```python
import torch

def _softmax(x, axis=-1):
    return torch.softmax(x, dim=axis)
def _gelu(x):
    return torch.nn.functional.gelu(x, approximate="tanh")
def _silu(x):
    return torch.nn.functional.silu(x)
def _sigmoid(x):
    return torch.sigmoid(x)
def _layernorm(x, axis=-1, eps=1e-5):
    m = x.mean(dim=axis, keepdim=True)
    v = x.var(dim=axis, keepdim=True, unbiased=False)
    return (x - m) / torch.sqrt(v + eps)
def _scatter_add(tgt, idx, src, axis=0):
    return tgt.clone().index_add_(axis, idx, src)
def _segment_sum(src, seg, n):
    out = torch.zeros((n,) + src.shape[1:], dtype=src.dtype)
    return out.index_add_(0, seg, src)
def _pad(x, pw):
    flat = tuple(v for pair in reversed(pw) for v in pair)
    return torch.nn.functional.pad(x, flat)

kernel_name = 'sequential_preLN__mha_block_cached__glu_gated_geglu__decode'

def setup_inputs():

    _w = (lambda a: (lambda t: t.to(torch.bfloat16) if t.is_floating_point() else t)(torch.as_tensor(a)))
    def _A_setup():
        B, Sq, D = 4, 1, 448
        H, Sk, Dh = 16, 4096, 256
        return {
            "x": _w((lambda *s: torch.randn(*s, dtype=torch.bfloat16) * 0.05)(B, Sq, D)),
            "k_cache": _w((lambda *s: torch.randn(*s, dtype=torch.bfloat16) * 1.6)(B, H, Sk, Dh)),
            "v_cache": _w((lambda *s: torch.randn(*s, dtype=torch.bfloat16) * 0.8)(B, H, Sk, Dh)),
            "wq": _w((lambda *s: torch.randn(*s, dtype=torch.bfloat16) * 1.6)(D, H * Dh) * (D ** -0.5)),
            "wo": _w((lambda *s: torch.randn(*s, dtype=torch.bfloat16) * 0.8)(H * Dh, D) * ((H * Dh) ** -0.5)),
        }
    _A_in = _A_setup()

    def _B_setup():
        B, S, Dm, Df = 4, 1, 448, 1792
        return {
            "x": _w((lambda *s: torch.randn(*s, dtype=torch.bfloat16) * 0.05)(B, S, Dm)),
            "w_gate": _w((lambda *s: torch.randn(*s, dtype=torch.bfloat16) * 0.8)(Dm, Df) * (Dm ** -0.5)),
            "w_up": _w((lambda *s: torch.randn(*s, dtype=torch.bfloat16) * 0.8)(Dm, Df) * (Dm ** -0.5)),
            "w_down": _w((lambda *s: torch.randn(*s, dtype=torch.bfloat16) * 0.8)(Df, Dm) * (Df ** -0.5)),
        }
    _B_in = _B_setup()

    return {
        "A_x": _A_in["x"],
        "A_k_cache": _A_in["k_cache"],
        "A_v_cache": _A_in["v_cache"],
        "A_wq": _A_in["wq"],
        "A_wo": _A_in["wo"],
        "B_x": _B_in["x"],
        "B_w_gate": _B_in["w_gate"],
        "B_w_up": _B_in["w_up"],
        "B_w_down": _B_in["w_down"],
    }

def reference(A_x, A_k_cache, A_v_cache, A_wq, A_wo, B_x, B_w_gate, B_w_up, B_w_down):
    def _A_ref(x, k_cache, v_cache, wq, wo):
        B, Sq, D = x.shape
        H, Dh = 16, 256
        q = (lambda x, *d: x.permute(*d))((x @ wq).reshape(B, Sq, H, Dh), 0, 2, 1, 3)
        scores = torch.einsum("bhqd,bhkd->bhqk", q, k_cache) * (Dh ** -0.5)
        p = _softmax(scores, axis=-1)
        o = torch.einsum("bhqk,bhkd->bhqd", p, v_cache)
        return (lambda x, *d: x.permute(*d))(o, 0, 2, 1, 3).reshape(B, Sq, H * Dh) @ wo

    def _B_ref(x, w_gate, w_up, w_down):
        g = torch.einsum("bsd,df->bsf", x, w_gate)
        u = torch.einsum("bsd,df->bsf", x, w_up)
        h = _gelu(g) * u
        return torch.einsum("bsf,fd->bsd", h, w_down)

    x = A_x
    h = x + _A_ref(_layernorm(x, axis=-1), A_k_cache, A_v_cache, A_wq, A_wo)
    h2 = h + _B_ref(_layernorm(h, axis=-1), B_w_gate, B_w_up, B_w_down)
    return h2
```

```asm
; @launch grid=(256,1,1) block=(256,1,1) lds=80384
.amdgcn_target "amdgcn-amd-amdhsa--gfx950"
.text
.globl sequential_preLN__mha_block_cached__glu_gated_geglu__decode_kernel
.p2align 12
.p2align 8
.type sequential_preLN__mha_block_cached__glu_gated_geglu__decode_kernel,@function
sequential_preLN__mha_block_cached__glu_gated_geglu__decode_kernel:
  s_cmp_ge_u32 s2, 256
  s_cbranch_scc1 L_exit
  s_load_dwordx16 s[48:63], s[0:1], 0
  s_load_dwordx8 s[64:71], s[0:1], 64
  v_lshrrev_b32 v1, 6, v0
  s_nop 0
  v_readfirstlane_b32 s4, v1
  v_and_b32 v1, 63, v0
  s_lshr_b32 s6, s2, 5
  s_bfe_u32 s7, s2, 0x20003
  s_bfe_u32 s5, s2, 0x10002
  s_lshl_b32 s5, s5, 1
  s_and_b32 s22, s2, 1
  s_add_u32 s5, s5, s22
  s_lshr_b32 s22, s2, 1
  s_xor_b32 s22, s22, s6
  s_and_b32 s74, s22, 1
  s_lshr_b32 s22, s6, 1
  s_add_u32 s22, s22, s5
  s_and_b32 s22, s22, 3
  s_lshl_b32 s73, s6, 2
  s_add_u32 s22, s73, s22
  s_lshl_b32 s22, s22, 2
  s_add_u32 s22, s22, s7
  s_add_u32 s73, s73, s7
  s_cmp_eq_u32 s74, 1
  s_cselect_b32 s75, s22, s5
  s_cmp_lt_u32 s2, 224
  s_cselect_b32 s74, s74, 3
  v_bfe_u32 v2, v1, 2, 2
  v_lshlrev_b32 v2, 9, v2
  v_lshrrev_b32 v8, 4, v1
  v_lshl_add_u32 v2, v8, 6, v2
  v_and_b32 v9, 3, v1
  v_lshl_add_u32 v2, v9, 4, v2
  v_and_b32 v6, 15, v1
  v_lshlrev_b32 v3, 4, v6
  v_lshl_add_u32 v3, v8, 9, v3
  v_lshlrev_b32 v15, 3, v1
  v_mov_b32 v7, 0x40000000
  v_cmp_gt_u32 vcc, 56, v1
  s_nop 1
  v_cndmask_b32 v15, v7, v15, vcc
  v_bfe_u32 v4, v1, 1, 2
  v_xor_b32 v4, v4, v8
  v_lshlrev_b32 v4, 5, v4
  v_and_b32 v5, 1, v1
  v_lshl_add_u32 v4, v5, 4, v4
  v_lshrrev_b32 v5, 3, v1
  v_lshl_add_u32 v4, v5, 13, v4
  v_mov_b32 v7, 0
  s_lshr_b32 s5, s2, 2
  s_lshl_b32 s20, s5, 21
  s_and_b32 s6, s2, 3
  s_lshl_b32 s7, s6, 2
  s_add_u32 s7, s7, s4
  s_lshl_b32 s7, s7, 12
  s_add_u32 s20, s20, s7
  s_mov_b32 s21, s20
  s_lshl2_add_u32 s7, s6, s4
  s_add_u32 s7, s7, s5
  s_and_b32 s7, s7, 15
  s_lshl_b32 s7, s7, 12
  s_lshl_b32 s20, s5, 21
  s_add_u32 s20, s20, s7
  s_mov_b32 s21, s20
  s_lshl_b32 s22, s4, 2
  s_min_u32 s22, s22, 10
  s_mul_i32 s23, s6, 14
  s_add_u32 s23, s23, s22
  s_lshl_b32 s23, s23, 16
  s_lshl_b32 s7, s5, 7
  s_add_u32 s23, s23, s7
  s_lshl_b32 s22, s22, 10
  s_add_u32 s22, s22, 48384
  s_mul_i32 s24, s4, 896
  s_mov_b32 s11, 0x20000
  s_mov_b32 s15, 0x20000
  s_mov_b32 s19, 0x20000
  s_mov_b32 s47, 0x20000
  s_mov_b32 s79, 0x20000
  s_mov_b32 s83, 0x20000
  s_mov_b32 s10, 0x8000000
  s_mov_b32 s14, 0x8000000
  s_mov_b32 s18, 0x400000
  s_mov_b32 s46, 3584
  s_mov_b32 s78, 3670016
  s_waitcnt lgkmcnt(0)
  s_mov_b32 s8, s50
  s_mov_b32 s9, s51
  buffer_load_dwordx4 v[68:71], v2, s[8:11], s20 offen offset:0 nt
  buffer_load_dwordx4 v[72:75], v2, s[8:11], s20 offen offset:256 nt
  buffer_load_dwordx4 v[76:79], v2, s[8:11], s20 offen offset:2048 nt
  buffer_load_dwordx4 v[80:83], v2, s[8:11], s20 offen offset:2304 nt
  s_add_u32 s20, s20, 65536
  s_mov_b32 s16, s70
  s_mov_b32 s17, s71
  s_mov_b32 s44, s48
  s_mov_b32 s45, s49
  s_mov_b32 s76, s54
  s_mov_b32 s77, s55
  buffer_load_dwordx2 v[196:197], v15, s[44:47], s24 offen
  buffer_load_dwordx2 v[198:199], v15, s[44:47], s24 offen offset:448
  s_bfe_u32 s25, s2, 0x20002
  s_lshl_b32 s25, s25, 4
  s_lshr_b32 s26, s2, 4
  s_add_u32 s25, s25, s26
  s_mul_i32 s25, s25, 256
  s_add_u32 s25, s25, 1441792
  s_cmp_eq_u32 s6, 0
  s_cselect_b32 s25, s25, 4194304
  s_mov_b64 exec, 1
  buffer_store_dword v7, v7, s[16:19], s25 offen sc1
  s_mov_b64 exec, -1
  s_mul_i32 s25, s5, 256
  s_add_u32 s25, s25, 1441792
  s_add_u32 s40, s70, s25
  s_addc_u32 s41, s71, 0
  s_lshl_b32 s3, s5, 21
  s_mov_b32 m0, s22
  s_nop 0
  buffer_load_dwordx4 v4, s[76:79], s23 offen nt lds
  s_add_u32 s22, s22, 1024
  s_add_u32 s23, s23, 65536
  s_mov_b32 m0, s22
  s_nop 0
  buffer_load_dwordx4 v4, s[76:79], s23 offen nt lds
  s_add_u32 s22, s22, 1024
  s_add_u32 s23, s23, 65536
  s_mov_b32 m0, s22
  s_nop 0
  buffer_load_dwordx4 v4, s[76:79], s23 offen nt lds
  s_add_u32 s22, s22, 1024
  s_add_u32 s23, s23, 65536
  s_mov_b32 m0, s22
  s_nop 0
  buffer_load_dwordx4 v4, s[76:79], s23 offen nt lds
  buffer_load_dword v14, v7, s[16:19], 0 offen sc1
  s_mov_b32 s8, s50
  s_mov_b32 s9, s51
  s_mov_b32 s12, s52
  s_mov_b32 s13, s53
  buffer_load_dwordx4 v[84:87], v2, s[8:11], s20 offen offset:0 nt
  buffer_load_dwordx4 v[88:91], v2, s[8:11], s20 offen offset:256 nt
  buffer_load_dwordx4 v[92:95], v2, s[8:11], s20 offen offset:2048 nt
  buffer_load_dwordx4 v[96:99], v2, s[8:11], s20 offen offset:2304 nt
  s_add_u32 s20, s20, 65536
  v_and_b32 v6, 15, v1
  v_cmp_eq_u32 vcc, 0, v6
  v_mov_b32 v5, 0xffff
  s_nop 0
  v_cndmask_b32 v10, 0, v5, vcc
  v_cmp_eq_u32 vcc, 1, v6
  v_mov_b32 v5, 0xffff0000
  s_nop 0
  v_cndmask_b32 v10, v10, v5, vcc
  v_cmp_eq_u32 vcc, 2, v6
  v_mov_b32 v5, 0xffff
  s_nop 0
  v_cndmask_b32 v11, 0, v5, vcc
  v_cmp_eq_u32 vcc, 3, v6
  v_mov_b32 v5, 0xffff0000
  s_nop 0
  v_cndmask_b32 v11, v11, v5, vcc
  v_cmp_eq_u32 vcc, 4, v6
  v_mov_b32 v5, 0xffff
  s_nop 0
  v_cndmask_b32 v12, 0, v5, vcc
  v_cmp_eq_u32 vcc, 5, v6
  v_mov_b32 v5, 0xffff0000
  s_nop 0
  v_cndmask_b32 v12, v12, v5, vcc
  v_cmp_eq_u32 vcc, 6, v6
  v_mov_b32 v5, 0xffff
  s_nop 0
  v_cndmask_b32 v13, 0, v5, vcc
  v_cmp_eq_u32 vcc, 7, v6
  v_mov_b32 v5, 0xffff0000
  s_nop 0
  v_cndmask_b32 v13, v13, v5, vcc
  s_mov_b32 s30, 0x22222222
  s_mov_b32 s31, 0x22222222
  s_mov_b32 s32, 0x44444444
  s_mov_b32 s33, 0x44444444
  s_mov_b32 s34, 0x88888888
  s_mov_b32 s35, 0x88888888
  s_mov_b32 s36, 0x3db8aa3b
  s_mov_b32 s42, 0xffffff00
  s_mov_b32 s43, 65536
  s_movk_i32 s48, 0xff
  s_mov_b32 s49, 0xffff
  s_mov_b32 s50, 0x05040100
  s_mov_b32 s51, 0x07060100
  s_mov_b32 s52, 0x07060302
  s_mov_b32 s53, 0x3f803f80
  s_mov_b64 s[68:69], -1
  v_lshlrev_b32 v231, 2, v1
  v_mov_b32 v232, -1
  s_and_b32 s5, s2, 3
  v_mov_b32 v233, s5
  v_cmp_eq_u32 vcc, 16, v1
  s_nop 1
  v_cndmask_b32 v232, v232, v233, vcc
  v_cmp_ne_u32 vcc, 0, v1
  s_nop 1
  v_cndmask_b32 v232, 0, v232, vcc
  s_cmp_eq_u32 s4, 0
  s_cselect_b64 exec, -1, 0
  ds_write_b32 v231, v232 offset:40960
  v_mov_b32 v232, -1
  ds_write_b32 v231, v232 offset:41216
  s_mov_b64 exec, -1
  v_mov_b32 v231, 0
  v_mov_b32 v232, 1
  s_mov_b32 s55, -1
  s_waitcnt vmcnt(10)
  v_lshlrev_b32 v36, 16, v196
  v_and_b32 v37, 0xffff0000, v196
  v_lshlrev_b32 v38, 16, v197
  v_and_b32 v39, 0xffff0000, v197
  v_lshlrev_b32 v40, 16, v198
  v_and_b32 v41, 0xffff0000, v198
  v_lshlrev_b32 v42, 16, v199
  v_and_b32 v43, 0xffff0000, v199
  v_add_f32 v44, v36, v37
  v_add_f32 v45, v38, v39
  v_add_f32 v46, v40, v41
  v_add_f32 v44, v44, v42
  v_add_f32 v45, v45, v43
  v_add_f32 v44, v44, v46
  v_add_f32 v44, v44, v45
  s_nop 1
  v_add_f32_dpp v44, v44, v44 quad_perm:[1,0,3,2] row_mask:0xf bank_mask:0xf
  s_nop 1
  v_add_f32_dpp v44, v44, v44 quad_perm:[2,3,0,1] row_mask:0xf bank_mask:0xf
  s_nop 1
  v_add_f32_dpp v44, v44, v44 row_half_mirror row_mask:0xf bank_mask:0xf
  s_nop 1
  v_add_f32_dpp v44, v44, v44 row_mirror row_mask:0xf bank_mask:0xf
  s_nop 1
  v_add_f32_dpp v44, v44, v44 row_bcast:15 row_mask:0xa bank_mask:0xf
  s_nop 1
  v_add_f32_dpp v44, v44, v44 row_bcast:31 row_mask:0xc bank_mask:0xf
  s_nop 0
  v_readlane_b32 s38, v44, 63
  v_mov_b32 v45, 0x3b124925
  v_mov_b32 v44, 0
  v_mul_f32 v45, s38, v45
  s_mov_b32 exec_hi, 0x00ffffff
  v_sub_f32 v46, v36, v45
  v_fmac_f32 v44, v46, v46
  v_sub_f32 v46, v37, v45
  v_fmac_f32 v44, v46, v46
  v_sub_f32 v46, v38, v45
  v_fmac_f32 v44, v46, v46
  v_sub_f32 v46, v39, v45
  v_fmac_f32 v44, v46, v46
  v_sub_f32 v46, v40, v45
  v_fmac_f32 v44, v46, v46
  v_sub_f32 v46, v41, v45
  v_fmac_f32 v44, v46, v46
  v_sub_f32 v46, v42, v45
  v_fmac_f32 v44, v46, v46
  v_sub_f32 v46, v43, v45
  v_fmac_f32 v44, v46, v46
  s_mov_b64 exec, -1
  v_cvt_pk_bf16_f32 v45, v45, v45
  v_and_b32 v45, 0xffff0000, v45
  v_sub_f32 v36, v36, v45
  v_sub_f32 v37, v37, v45
  v_sub_f32 v38, v38, v45
  v_sub_f32 v39, v39, v45
  v_sub_f32 v40, v40, v45
  v_sub_f32 v41, v41, v45
  v_sub_f32 v42, v42, v45
  v_sub_f32 v43, v43, v45
  v_add_f32_dpp v44, v44, v44 quad_perm:[1,0,3,2] row_mask:0xf bank_mask:0xf
  s_nop 1
  v_add_f32_dpp v44, v44, v44 quad_perm:[2,3,0,1] row_mask:0xf bank_mask:0xf
  s_nop 1
  v_add_f32_dpp v44, v44, v44 row_half_mirror row_mask:0xf bank_mask:0xf
  s_nop 1
  v_add_f32_dpp v44, v44, v44 row_mirror row_mask:0xf bank_mask:0xf
  s_nop 1
  v_add_f32_dpp v44, v44, v44 row_bcast:15 row_mask:0xa bank_mask:0xf
  s_nop 1
  v_add_f32_dpp v44, v44, v44 row_bcast:31 row_mask:0xc bank_mask:0xf
  s_nop 0
  v_readlane_b32 s39, v44, 63
  v_cvt_pk_bf16_f32 v36, v36, v36
  v_and_b32 v36, 0xffff0000, v36
  v_cvt_pk_bf16_f32 v37, v37, v37
  v_and_b32 v37, 0xffff0000, v37
  v_cvt_pk_bf16_f32 v38, v38, v38
  v_and_b32 v38, 0xffff0000, v38
  v_cvt_pk_bf16_f32 v39, v39, v39
  v_and_b32 v39, 0xffff0000, v39
  v_cvt_pk_bf16_f32 v40, v40, v40
  v_and_b32 v40, 0xffff0000, v40
  v_cvt_pk_bf16_f32 v41, v41, v41
  v_and_b32 v41, 0xffff0000, v41
  v_cvt_pk_bf16_f32 v42, v42, v42
  v_and_b32 v42, 0xffff0000, v42
  v_cvt_pk_bf16_f32 v43, v43, v43
  v_and_b32 v43, 0xffff0000, v43
  v_mov_b32 v44, 0x3b124925
  v_mul_f32 v44, s39, v44
  v_cvt_pk_bf16_f32 v44, v44, v44
  v_and_b32 v44, 0xffff0000, v44
  v_add_f32 v44, 0x3727c5ac, v44
  v_cvt_pk_bf16_f32 v44, v44, v44
  v_and_b32 v44, 0xffff0000, v44
  v_sqrt_f32 v44, v44
  s_nop 0
  v_cvt_pk_bf16_f32 v44, v44, v44
  v_and_b32 v44, 0xffff0000, v44
  v_rcp_f32 v44, v44
  s_nop 0
  v_mul_f32 v36, v36, v44
  v_mul_f32 v37, v37, v44
  v_mul_f32 v38, v38, v44
  v_mul_f32 v39, v39, v44
  v_mul_f32 v40, v40, v44
  v_mul_f32 v41, v41, v44
  v_mul_f32 v42, v42, v44
  v_mul_f32 v43, v43, v44
  v_cvt_pk_bf16_f32 v48, v36, v37
  v_cvt_pk_bf16_f32 v49, v38, v39
  v_cvt_pk_bf16_f32 v50, v40, v41
  v_cvt_pk_bf16_f32 v51, v42, v43
  s_mul_i32 s5, s4, 960
  s_add_u32 s5, s5, 0
  v_lshlrev_b32 v44, 3, v1
  v_add_u32 v44, s5, v44
  s_mov_b32 exec_hi, 0x00ffffff
  ds_write_b64 v44, v[48:49]
  ds_write_b64 v44, v[50:51] offset:448
  s_mov_b64 exec, -1
  v_bfe_u32 v44, v1, 3, 2
  v_xor_b32 v44, s4, v44
  v_lshlrev_b32 v44, 5, v44
  v_lshrrev_b32 v45, 2, v1
  v_lshl_add_u32 v44, v45, 7, v44
  v_and_b32 v45, 3, v1
  v_lshl_add_u32 v44, v45, 3, v44
  v_mul_u32_u24 v45, 960, v45
  v_lshrrev_b32 v46, 4, v1
  v_lshl_add_u32 v45, v46, 3, v45
  s_and_b32 s5, s2, 3
  s_mul_i32 s5, s5, 224
  v_add_u32 v45, s5, v45
  v_and_b32 v47, 15, v1
  v_lshlrev_b32 v47, 12, v47
  v_lshl_add_u32 v47, v46, 4, v47
  s_lshr_b32 s5, s2, 4
  s_lshl_b32 s5, s5, 14
  s_and_b32 s6, s2, 15
  s_lshl_b32 s6, s6, 8
  s_add_u32 s5, s5, s6
  s_lshl_b32 s6, s4, 6
  s_add_u32 s5, s5, s6
  s_add_u32 s5, s5, 4096
  s_waitcnt vmcnt(4)
  buffer_load_dwordx4 v[100:103], v2, s[8:11], s20 offen offset:0 nt
  buffer_load_dwordx4 v[104:107], v2, s[8:11], s20 offen offset:256 nt
  buffer_load_dwordx4 v[108:111], v2, s[8:11], s20 offen offset:2048 nt
  buffer_load_dwordx4 v[112:115], v2, s[8:11], s20 offen offset:2304 nt
  s_add_u32 s20, s20, 65536
  v_add_u32 v14, 1, v14
  s_nop 0
  v_readfirstlane_b32 s72, v14
  s_waitcnt lgkmcnt(0)
  s_barrier
  ds_read_b64_tr_b16 v[52:53], v44 offset:48384
  ds_read_b64 v[20:21], v45 offset:0
  ds_read_b64_tr_b16 v[54:55], v44 offset:50432
  ds_read_b64 v[22:23], v45 offset:32
  ds_read_b64_tr_b16 v[56:57], v44 offset:52480
  ds_read_b64 v[24:25], v45 offset:64
  ds_read_b64_tr_b16 v[58:59], v44 offset:54528
  ds_read_b64 v[26:27], v45 offset:96
  ds_read_b64_tr_b16 v[60:61], v44 offset:56576
  ds_read_b64 v[28:29], v45 offset:128
  ds_read_b64_tr_b16 v[62:63], v44 offset:58624
  ds_read_b64 v[30:31], v45 offset:160
  ds_read_b64_tr_b16 v[64:65], v44 offset:60672
  ds_read_b64 v[32:33], v45 offset:192
  s_waitcnt lgkmcnt(0)
  v_mfma_f32_16x16x16_bf16 v[16:19], v[52:53], v[20:21], 0
  v_mfma_f32_16x16x16_bf16 v[16:19], v[54:55], v[22:23], v[16:19]
  v_mfma_f32_16x16x16_bf16 v[16:19], v[56:57], v[24:25], v[16:19]
  v_mfma_f32_16x16x16_bf16 v[16:19], v[58:59], v[26:27], v[16:19]
  v_mfma_f32_16x16x16_bf16 v[16:19], v[60:61], v[28:29], v[16:19]
  v_mfma_f32_16x16x16_bf16 v[16:19], v[62:63], v[30:31], v[16:19]
  v_mfma_f32_16x16x16_bf16 v[16:19], v[64:65], v[32:33], v[16:19]
  s_nop 7
  v_bfi_b32 v16, s48, v14, v16
  v_bfi_b32 v17, s48, v14, v17
  v_bfi_b32 v18, s48, v14, v18
  v_bfi_b32 v19, s48, v14, v19
  s_mov_b32 exec_lo, 0x000f000f
  s_mov_b32 exec_hi, 0x000f000f
  buffer_store_dwordx4 v[16:19], v47, s[16:19], s5 offen sc1
  s_mov_b64 exec, -1
  buffer_load_dwordx4 v[116:119], v2, s[8:11], s20 offen offset:0 nt
  buffer_load_dwordx4 v[120:123], v2, s[8:11], s20 offen offset:256 nt
  buffer_load_dwordx4 v[124:127], v2, s[8:11], s20 offen offset:2048 nt
  buffer_load_dwordx4 v[128:131], v2, s[8:11], s20 offen offset:2304 nt
  s_add_u32 s20, s20, 65536
  s_branch L_tchA
L_tchAr:
  s_waitcnt vmcnt(4)
  s_and_b32 s25, s2, 3
  s_lshl_b32 s25, s25, 2
  s_lshr_b32 s26, s2, 6
  s_add_u32 s25, s25, s26
  s_bfe_u32 s26, s2, 0x40002
  s_mul_i32 s26, s26, 10240
  s_add_u32 s26, s26, 266240
  s_lshl_b32 s27, s25, 9
  s_add_u32 s27, s27, s26
  s_lshl_b32 s28, s25, 7
  s_add_u32 s28, s28, s26
  s_add_u32 s28, s28, 7680
  s_mul_i32 s29, s75, 3584
  s_lshr_b32 s25, s73, 1
  s_mul_i32 s25, s25, 0
  s_add_u32 s29, s29, s25
  s_lshl_b32 s25, s73, 7
  s_add_u32 s29, s29, s25
  s_add_u32 s29, s29, 2096512
  v_mov_b32 v208, s27
  v_mov_b32 v209, s28
  v_cmp_le_u32 vcc, 32, v1
  s_nop 1
  v_cndmask_b32 v208, v208, v209, vcc
  v_mov_b32 v209, s29
  v_cmp_le_u32 vcc, 40, v1
  s_nop 1
  v_cndmask_b32 v208, v208, v209, vcc
  v_lshl_add_u32 v208, v1, 4, v208
  v_mov_b32 v204, -1
  v_mov_b32 v205, -1
  v_mov_b32 v206, -1
  v_mov_b32 v207, -1
  s_movk_i32 s29, 0xff
  s_cmp_eq_u32 s74, 0
  s_cselect_b32 s29, 65535, s29
  s_mov_b32 s28, -1
  s_cmp_eq_u32 s4, 0
  s_cselect_b64 s[28:29], s[28:29], 0
  s_mov_b64 exec, s[28:29]
  buffer_store_dwordx4 v[204:207], v208, s[16:19], 0 offen sc1
  s_mov_b64 exec, -1
  v_lshrrev_b32 v208, 3, v1
  v_mul_u32_u24 v208, 14464, v208
  v_lshl_add_u32 v208, v1, 4, v208
  s_mul_i32 s27, s75, 3584
  s_lshr_b32 s25, s73, 1
  s_mul_i32 s25, s25, 0
  s_add_u32 s27, s27, s25
  s_lshl_b32 s25, s73, 7
  s_add_u32 s27, s27, s25
  s_add_u32 s27, s27, 2097152
  s_lshl_b32 s25, s75, 7
  s_add_u32 s25, s25, 2621440
  s_cmp_eq_u32 s74, 1
  s_cselect_b32 s27, s25, s27
  s_lshr_b32 s25, s74, 1
  s_or_b32 s25, s25, s4
  s_cselect_b32 s25, 0x40000000, 0
  v_add_u32 v208, s25, v208
  buffer_store_dwordx4 v[204:207], v208, s[16:19], s27 offen sc1
  s_mov_b64 exec, -1
  v_lshlrev_b32 v208, 4, v1
  v_add_u32 v208, 520192, v208
  s_lshr_b32 s5, s2, 2
  s_and_b32 s6, s5, 15
  s_lshl_b32 s6, s6, 14
  s_lshr_b32 s5, s5, 4
  s_lshl_b32 s5, s5, 12
  s_add_u32 s26, s5, s6
  s_lshl_b32 s5, s4, 10
  s_add_u32 s26, s26, s5
  s_add_u32 s26, s26, 4096
  v_lshlrev_b32 v40, 4, v1
  buffer_load_dwordx4 v[36:39], v40, s[16:19], s26 offen sc1
  buffer_load_dwordx4 v[132:135], v2, s[8:11], s20 offen offset:0 nt
  buffer_load_dwordx4 v[136:139], v2, s[8:11], s20 offen offset:256 nt
  buffer_load_dwordx4 v[140:143], v2, s[8:11], s20 offen offset:2048 nt
  buffer_load_dwordx4 v[144:147], v2, s[8:11], s20 offen offset:2304 nt
  s_add_u32 s20, s20, 65536
  s_waitcnt vmcnt(4)
  v_bitop3_b32 v41, v36, v37, s72 bitop3:0x7e
  v_bitop3_b32 v42, v38, v39, s72 bitop3:0x7e
  v_bitop3_b32 v41, v41, v42, s48 bitop3:0xa8
  v_cmp_ne_u32 vcc, 0, v41
  s_cbranch_vccz L_qt_1
  buffer_load_dwordx4 v[36:39], v40, s[16:19], s26 offen sc1
L_qt_1:
  buffer_load_dwordx4 v[148:151], v2, s[8:11], s20 offen offset:0 nt
  buffer_load_dwordx4 v[152:155], v2, s[8:11], s20 offen offset:256 nt
  buffer_load_dwordx4 v[156:159], v2, s[8:11], s20 offen offset:2048 nt
  buffer_load_dwordx4 v[160:163], v2, s[8:11], s20 offen offset:2304 nt
  s_add_u32 s20, s20, 65536
  s_waitcnt vmcnt(4)
  v_bitop3_b32 v41, v36, v37, s72 bitop3:0x7e
  v_bitop3_b32 v42, v38, v39, s72 bitop3:0x7e
  v_bitop3_b32 v41, v41, v42, s48 bitop3:0xa8
  v_cmp_ne_u32 vcc, 0, v41
  s_cbranch_vccz L_qt_2
  buffer_load_dwordx4 v[36:39], v40, s[16:19], s26 offen sc1
L_qt_2:
  buffer_load_dwordx4 v[164:167], v2, s[8:11], s20 offen offset:0 nt
  buffer_load_dwordx4 v[168:171], v2, s[8:11], s20 offen offset:256 nt
  buffer_load_dwordx4 v[172:175], v2, s[8:11], s20 offen offset:2048 nt
  buffer_load_dwordx4 v[176:179], v2, s[8:11], s20 offen offset:2304 nt
  s_add_u32 s20, s20, 65536
  s_waitcnt vmcnt(4)
  v_bitop3_b32 v41, v36, v37, s72 bitop3:0x7e
  v_bitop3_b32 v42, v38, v39, s72 bitop3:0x7e
  v_bitop3_b32 v41, v41, v42, s48 bitop3:0xa8
  v_cmp_ne_u32 vcc, 0, v41
  s_cbranch_vccz L_qt_3
  buffer_load_dwordx4 v[36:39], v40, s[16:19], s26 offen sc1
L_qt_3:
  buffer_load_dwordx4 v[180:183], v2, s[8:11], s20 offen offset:0 nt
  buffer_load_dwordx4 v[184:187], v2, s[8:11], s20 offen offset:256 nt
  buffer_load_dwordx4 v[188:191], v2, s[8:11], s20 offen offset:2048 nt
  buffer_load_dwordx4 v[192:195], v2, s[8:11], s20 offen offset:2304 nt
  s_add_u32 s20, s20, 65536
  s_waitcnt vmcnt(4)
  v_bitop3_b32 v41, v36, v37, s72 bitop3:0x7e
  v_bitop3_b32 v42, v38, v39, s72 bitop3:0x7e
  v_bitop3_b32 v41, v41, v42, s48 bitop3:0xa8
  v_cmp_ne_u32 vcc, 0, v41
  s_branch L_qchk
.p2align 12
L_tchA:
  s_branch L_tchAr
L_qchk:
  v_bitop3_b32 v41, v36, v37, s72 bitop3:0x7e
  v_bitop3_b32 v42, v38, v39, s72 bitop3:0x7e
  v_bitop3_b32 v41, v41, v42, s48 bitop3:0xa8
  v_cmp_ne_u32 vcc, 0, v41
  s_cbranch_vccz L_qok
  s_sub_u32 s43, s43, 1
  s_cbranch_scc1 L_qok
  buffer_load_dwordx4 v[36:39], v40, s[16:19], s26 offen sc1
  s_waitcnt vmcnt(0)
  s_branch L_qchk
L_qok:
  v_and_b32 v36, s42, v36
  v_and_b32 v37, s42, v37
  v_and_b32 v38, s42, v38
  v_and_b32 v39, s42, v39
  v_permlane16_swap_b32 v36, v37
  s_nop 0
  v_permlane16_swap_b32 v38, v39
  v_add_f32 v36, v36, v37
  v_add_f32 v38, v38, v39
  s_nop 1
  v_permlane32_swap_b32 v36, v38
  v_add_f32 v36, v36, v38
  v_cvt_pk_bf16_f32 v36, v36, v36
  v_and_b32 v41, 15, v1
  v_lshlrev_b32 v41, 3, v41
  v_lshrrev_b32 v42, 4, v1
  v_lshl_add_u32 v41, v42, 1, v41
  s_lshl_b32 s5, s4, 7
  v_add_u32 v41, s5, v41
  ds_write_b16 v41, v36 offset:4160
  v_and_b32 v43, 3, v1
  v_lshlrev_b32 v43, 4, v43
  v_lshl_add_u32 v43, v42, 6, v43
  s_waitcnt lgkmcnt(0)
  s_barrier
  ds_read_b128 v[28:31], v43 offset:4160
  ds_read_b128 v[32:35], v43 offset:4416
  v_bfe_u32 v6, v1, 2, 2
  v_mov_b32 v20, 0
  v_mov_b32 v21, 0
  v_mov_b32 v22, 0
  v_mov_b32 v23, 0
  v_mov_b32 v24, 0
  v_mov_b32 v25, 0
  v_mov_b32 v26, 0
  v_mov_b32 v27, 0
  v_mov_b32 v4, 0
  v_mov_b32 v5, 0xff800000
  v_cmp_eq_u32 s[22:23], 0, v6
  v_cmp_eq_u32 s[24:25], 1, v6
  v_cmp_eq_u32 s[26:27], 2, v6
  v_cmp_eq_u32 s[28:29], 3, v6
  s_waitcnt lgkmcnt(0)
  v_cndmask_b32 v36, 0, v28, s[22:23]
  v_cndmask_b32 v37, 0, v29, s[22:23]
  v_cndmask_b32 v38, 0, v30, s[22:23]
  v_cndmask_b32 v39, 0, v31, s[22:23]
  v_cndmask_b32 v40, 0, v32, s[22:23]
  v_cndmask_b32 v41, 0, v33, s[22:23]
  v_cndmask_b32 v42, 0, v34, s[22:23]
  v_cndmask_b32 v43, 0, v35, s[22:23]
  v_cndmask_b32 v44, 0, v28, s[24:25]
  v_cndmask_b32 v45, 0, v29, s[24:25]
  v_cndmask_b32 v46, 0, v30, s[24:25]
  v_cndmask_b32 v47, 0, v31, s[24:25]
  v_cndmask_b32 v48, 0, v32, s[24:25]
  v_cndmask_b32 v49, 0, v33, s[24:25]
  v_cndmask_b32 v50, 0, v34, s[24:25]
  v_cndmask_b32 v51, 0, v35, s[24:25]
  v_cndmask_b32 v52, 0, v28, s[26:27]
  v_cndmask_b32 v53, 0, v29, s[26:27]
  v_cndmask_b32 v54, 0, v30, s[26:27]
  v_cndmask_b32 v55, 0, v31, s[26:27]
  v_cndmask_b32 v56, 0, v32, s[26:27]
  v_cndmask_b32 v57, 0, v33, s[26:27]
  v_cndmask_b32 v58, 0, v34, s[26:27]
  v_cndmask_b32 v59, 0, v35, s[26:27]
  v_cndmask_b32 v60, 0, v28, s[28:29]
  v_cndmask_b32 v61, 0, v29, s[28:29]
  v_cndmask_b32 v62, 0, v30, s[28:29]
  v_cndmask_b32 v63, 0, v31, s[28:29]
  v_cndmask_b32 v64, 0, v32, s[28:29]
  v_cndmask_b32 v65, 0, v33, s[28:29]
  v_cndmask_b32 v66, 0, v34, s[28:29]
  v_cndmask_b32 v67, 0, v35, s[28:29]
  s_cmp_lg_u32 s4, 0
  s_cbranch_scc1 L_nf
  s_lshl_b32 s5, s2, 2
  s_add_u32 s5, s5, 520192
  s_mov_b32 s6, s72
  s_atomic_swap s6, s[70:71], s5
L_nf:
  v_lshrrev_b32 v200, 1, v1
  v_and_b32 v201, 1, v1
  v_lshlrev_b32 v201, 4, v201
  s_cmp_eq_u32 s74, 0
  s_cbranch_scc0 L_dmaN
  s_mov_b32 s76, s56
  s_mov_b32 s77, s57
  s_movk_i32 s22, 896
  v_mad_u32_u24 v200, v200, s22, v201
  s_lshl_b32 s22, s75, 2
  s_add_u32 s22, s22, s4
  s_mul_i32 s22, s22, 229376
  s_lshl_b32 s23, s73, 5
  s_add_u32 s22, s22, s23
  s_lshl_b32 s23, s4, 13
  s_add_u32 s23, s23, 5376
  s_bfe_u32 s24, s2, 0x20003
  s_mul_i32 s24, s24, 4
  s_lshr_b32 s24, s24, 2
  s_add_u32 s24, s24, 0
  s_lshl_b32 s25, s24, 10
  s_add_u32 m0, s23, s25
  s_mul_i32 s25, s24, 28672
  s_add_u32 s25, s25, s22
  buffer_load_dwordx4 v200, s[76:79], s25 offen lds
  s_add_u32 s24, s24, 1
  s_cmp_eq_u32 s24, 4
  s_cselect_b32 s24, 0, s24
  s_lshl_b32 s25, s24, 10
  s_add_u32 m0, s23, s25
  s_mul_i32 s25, s24, 28672
  s_add_u32 s25, s25, s22
  buffer_load_dwordx4 v200, s[76:79], s25 offen lds
  s_add_u32 s24, s24, 1
  s_cmp_eq_u32 s24, 4
  s_cselect_b32 s24, 0, s24
  s_lshl_b32 s25, s24, 10
  s_add_u32 m0, s23, s25
  s_mul_i32 s25, s24, 28672
  s_add_u32 s25, s25, s22
  buffer_load_dwordx4 v200, s[76:79], s25 offen lds
  s_add_u32 s24, s24, 1
  s_cmp_eq_u32 s24, 4
  s_cselect_b32 s24, 0, s24
  s_lshl_b32 s25, s24, 10
  s_add_u32 m0, s23, s25
  s_mul_i32 s25, s24, 28672
  s_add_u32 s25, s25, s22
  buffer_load_dwordx4 v200, s[76:79], s25 offen lds
  v_bfe_u32 v200, v1, 2, 2
  v_mul_u32_u24 v200, 896, v200
  v_and_b32 v201, 3, v1
  v_lshl_add_u32 v200, v201, 3, v200
  s_lshl_b32 s22, s73, 5
  s_cmp_eq_u32 s75, 0
  s_cselect_b32 s22, s22, 0x10000
  buffer_load_dwordx2 v[212:213], v200, s[44:47], s22 offen
  s_branch L_dmaE
L_dmaF:
  s_branch L_dmaE
L_dmaN:
L_dmaE:
  s_mov_b32 s37, 0
  s_mov_b32 s28, 0xff00ff00
  s_mov_b32 s29, 0xff00ff00
  s_mov_b32 s0, s8
  s_mov_b32 s1, s9
  v_mov_b32 v230, v2
  v_mov_b32 v200, 0xff800000
L_kl:
  v_mov_b32 v218, v222
  v_mov_b32 v219, v223
  v_mov_b32 v220, v224
  v_mov_b32 v221, v225
  v_mov_b32 v222, v226
  v_mov_b32 v223, v227
  v_mov_b32 v224, v228
  v_mov_b32 v225, v229
  s_waitcnt vmcnt(4)
  v_mfma_f32_16x16x32_bf16 v[16:19], v[68:71], v[36:39], 0
  v_mfma_f32_16x16x32_bf16 v[16:19], v[72:75], v[40:43], v[16:19]
  v_mfma_f32_16x16x32_bf16 v[16:19], v[76:79], v[44:47], v[16:19]
  v_mfma_f32_16x16x32_bf16 v[16:19], v[80:83], v[48:51], v[16:19]
  v_mfma_f32_16x16x32_bf16 v[16:19], v[84:87], v[52:55], v[16:19]
  v_mfma_f32_16x16x32_bf16 v[16:19], v[88:91], v[56:59], v[16:19]
  v_mfma_f32_16x16x32_bf16 v[16:19], v[92:95], v[60:63], v[16:19]
  v_mfma_f32_16x16x32_bf16 v[16:19], v[96:99], v[64:67], v[16:19]
  buffer_load_dwordx4 v[68:71], v230, s[8:11], s20 offen offset:0 nt
  buffer_load_dwordx4 v[72:75], v230, s[8:11], s20 offen offset:256 nt
  buffer_load_dwordx4 v[76:79], v230, s[8:11], s20 offen offset:2048 nt
  buffer_load_dwordx4 v[80:83], v230, s[8:11], s20 offen offset:2304 nt
  s_add_u32 s20, s20, 65536
  s_waitcnt vmcnt(4)
  buffer_load_dwordx4 v[84:87], v230, s[8:11], s20 offen offset:0 nt
  buffer_load_dwordx4 v[88:91], v230, s[8:11], s20 offen offset:256 nt
  buffer_load_dwordx4 v[92:95], v230, s[8:11], s20 offen offset:2048 nt
  buffer_load_dwordx4 v[96:99], v230, s[8:11], s20 offen offset:2304 nt
  s_add_u32 s20, s20, 65536
  v_cndmask_b32 v226, v16, v17, s[30:31]
  v_cndmask_b32 v226, v226, v18, s[32:33]
  v_cndmask_b32 v226, v226, v19, s[34:35]
  s_nop 1
  v_add_f32_dpp v226, v226, v226 quad_perm:[1,0,3,2] row_mask:0xf bank_mask:0xf
  s_nop 1
  v_add_f32_dpp v226, v226, v226 quad_perm:[2,3,0,1] row_mask:0xf bank_mask:0xf
  v_cvt_pk_bf16_f32 v226, v226, v226
  v_and_b32 v226, 0xffff0000, v226
  s_waitcnt vmcnt(4)
  v_mfma_f32_16x16x32_bf16 v[16:19], v[100:103], v[36:39], 0
  v_mfma_f32_16x16x32_bf16 v[16:19], v[104:107], v[40:43], v[16:19]
  v_mfma_f32_16x16x32_bf16 v[16:19], v[108:111], v[44:47], v[16:19]
  v_mfma_f32_16x16x32_bf16 v[16:19], v[112:115], v[48:51], v[16:19]
  v_mfma_f32_16x16x32_bf16 v[16:19], v[116:119], v[52:55], v[16:19]
  v_mfma_f32_16x16x32_bf16 v[16:19], v[120:123], v[56:59], v[16:19]
  v_mfma_f32_16x16x32_bf16 v[16:19], v[124:127], v[60:63], v[16:19]
  v_mfma_f32_16x16x32_bf16 v[16:19], v[128:131], v[64:67], v[16:19]
  buffer_load_dwordx4 v[100:103], v230, s[8:11], s20 offen offset:0 nt
  buffer_load_dwordx4 v[104:107], v230, s[8:11], s20 offen offset:256 nt
  buffer_load_dwordx4 v[108:111], v230, s[8:11], s20 offen offset:2048 nt
  buffer_load_dwordx4 v[112:115], v230, s[8:11], s20 offen offset:2304 nt
  s_add_u32 s20, s20, 65536
  s_waitcnt vmcnt(4)
  buffer_load_dwordx4 v[116:119], v230, s[8:11], s20 offen offset:0 nt
  buffer_load_dwordx4 v[120:123], v230, s[8:11], s20 offen offset:256 nt
  buffer_load_dwordx4 v[124:127], v230, s[8:11], s20 offen offset:2048 nt
  buffer_load_dwordx4 v[128:131], v230, s[8:11], s20 offen offset:2304 nt
  s_add_u32 s20, s20, 65536
  v_cndmask_b32 v227, v16, v17, s[30:31]
  v_cndmask_b32 v227, v227, v18, s[32:33]
  v_cndmask_b32 v227, v227, v19, s[34:35]
  s_nop 1
  v_add_f32_dpp v227, v227, v227 quad_perm:[1,0,3,2] row_mask:0xf bank_mask:0xf
  s_nop 1
  v_add_f32_dpp v227, v227, v227 quad_perm:[2,3,0,1] row_mask:0xf bank_mask:0xf
  v_cvt_pk_bf16_f32 v227, v227, v227
  v_and_b32 v227, 0xffff0000, v227
  s_waitcnt vmcnt(4)
  v_mfma_f32_16x16x32_bf16 v[16:19], v[132:135], v[36:39], 0
  v_mfma_f32_16x16x32_bf16 v[16:19], v[136:139], v[40:43], v[16:19]
  v_mfma_f32_16x16x32_bf16 v[16:19], v[140:143], v[44:47], v[16:19]
  v_mfma_f32_16x16x32_bf16 v[16:19], v[144:147], v[48:51], v[16:19]
  v_mfma_f32_16x16x32_bf16 v[16:19], v[148:151], v[52:55], v[16:19]
  v_mfma_f32_16x16x32_bf16 v[16:19], v[152:155], v[56:59], v[16:19]
  v_mfma_f32_16x16x32_bf16 v[16:19], v[156:159], v[60:63], v[16:19]
  v_mfma_f32_16x16x32_bf16 v[16:19], v[160:163], v[64:67], v[16:19]
  buffer_load_dwordx4 v[132:135], v230, s[8:11], s20 offen offset:0 nt
  buffer_load_dwordx4 v[136:139], v230, s[8:11], s20 offen offset:256 nt
  buffer_load_dwordx4 v[140:143], v230, s[8:11], s20 offen offset:2048 nt
  buffer_load_dwordx4 v[144:147], v230, s[8:11], s20 offen offset:2304 nt
  s_add_u32 s20, s20, 65536
  s_waitcnt vmcnt(4)
  buffer_load_dwordx4 v[148:151], v230, s[8:11], s20 offen offset:0 nt
  buffer_load_dwordx4 v[152:155], v230, s[8:11], s20 offen offset:256 nt
  buffer_load_dwordx4 v[156:159], v230, s[8:11], s20 offen offset:2048 nt
  buffer_load_dwordx4 v[160:163], v230, s[8:11], s20 offen offset:2304 nt
  s_add_u32 s20, s20, 65536
  v_cndmask_b32 v228, v16, v17, s[30:31]
  v_cndmask_b32 v228, v228, v18, s[32:33]
  v_cndmask_b32 v228, v228, v19, s[34:35]
  s_nop 1
  v_add_f32_dpp v228, v228, v228 quad_perm:[1,0,3,2] row_mask:0xf bank_mask:0xf
  s_nop 1
  v_add_f32_dpp v228, v228, v228 quad_perm:[2,3,0,1] row_mask:0xf bank_mask:0xf
  v_cvt_pk_bf16_f32 v228, v228, v228
  v_and_b32 v228, 0xffff0000, v228
  s_waitcnt vmcnt(4)
  v_mfma_f32_16x16x32_bf16 v[16:19], v[164:167], v[36:39], 0
  v_mfma_f32_16x16x32_bf16 v[16:19], v[168:171], v[40:43], v[16:19]
  v_mfma_f32_16x16x32_bf16 v[16:19], v[172:175], v[44:47], v[16:19]
  v_mfma_f32_16x16x32_bf16 v[16:19], v[176:179], v[48:51], v[16:19]
  v_mfma_f32_16x16x32_bf16 v[16:19], v[180:183], v[52:55], v[16:19]
  v_mfma_f32_16x16x32_bf16 v[16:19], v[184:187], v[56:59], v[16:19]
  v_mfma_f32_16x16x32_bf16 v[16:19], v[188:191], v[60:63], v[16:19]
  v_mfma_f32_16x16x32_bf16 v[16:19], v[192:195], v[64:67], v[16:19]
  buffer_load_dwordx4 v[164:167], v230, s[8:11], s20 offen offset:0 nt
  buffer_load_dwordx4 v[168:171], v230, s[8:11], s20 offen offset:256 nt
  buffer_load_dwordx4 v[172:175], v230, s[8:11], s20 offen offset:2048 nt
  buffer_load_dwordx4 v[176:179], v230, s[8:11], s20 offen offset:2304 nt
  s_add_u32 s20, s20, 65536
  s_waitcnt vmcnt(4)
  buffer_load_dwordx4 v[180:183], v230, s[8:11], s20 offen offset:0 nt
  buffer_load_dwordx4 v[184:187], v230, s[8:11], s20 offen offset:256 nt
  buffer_load_dwordx4 v[188:191], v230, s[8:11], s20 offen offset:2048 nt
  buffer_load_dwordx4 v[192:195], v230, s[8:11], s20 offen offset:2304 nt
  s_add_u32 s20, s20, 65536
  v_cndmask_b32 v229, v16, v17, s[30:31]
  v_cndmask_b32 v229, v229, v18, s[32:33]
  v_cndmask_b32 v229, v229, v19, s[34:35]
  s_nop 1
  v_add_f32_dpp v229, v229, v229 quad_perm:[1,0,3,2] row_mask:0xf bank_mask:0xf
  s_nop 1
  v_add_f32_dpp v229, v229, v229 quad_perm:[2,3,0,1] row_mask:0xf bank_mask:0xf
  v_cvt_pk_bf16_f32 v229, v229, v229
  v_and_b32 v229, 0xffff0000, v229
  s_cmp_lg_u32 s37, 1
  s_cbranch_scc1 L_kn2
  s_mov_b32 s8, s12
  s_mov_b32 s9, s13
  s_mov_b32 s20, s21
  v_mov_b32 v230, v3
  buffer_load_dwordx4 v[204:207], v208, s[16:19], 0 offen sc1
L_kn2:
  s_add_u32 s37, s37, 1
  s_cmp_lt_u32 s37, 3
  s_cbranch_scc1 L_kl
  s_mov_b32 s21, s20
  s_mov_b32 s8, s0
  s_mov_b32 s9, s1
  v_max3_f32 v5, v218, v219, v220
  v_max_f32 v5, v5, v229
  v_max3_f32 v5, v5, v221, v222
  v_max3_f32 v5, v5, v223, v224
  v_max3_f32 v5, v5, v225, v226
  v_max3_f32 v5, v5, v227, v228
  s_nop 1
  v_max_f32_dpp v5, v5, v5 row_ror:4 row_mask:0xf bank_mask:0xf
  s_nop 1
  v_max_f32_dpp v5, v5, v5 row_ror:8 row_mask:0xf bank_mask:0xf
  s_nop 1
  v_max_f32_dpp v5, v5, v5 row_bcast:15 row_mask:0xa bank_mask:0xf
  s_nop 1
  v_max_f32_dpp v5, v5, v5 row_bcast:31 row_mask:0xc bank_mask:0xf
  s_nop 0
  v_readlane_b32 s38, v5, 63
  s_nop 1
  v_mov_b32 v5, s38
  v_sub_f32 v218, v218, v5
  v_sub_f32 v219, v219, v5
  v_sub_f32 v220, v220, v5
  v_sub_f32 v221, v221, v5
  v_sub_f32 v222, v222, v5
  v_sub_f32 v223, v223, v5
  v_sub_f32 v224, v224, v5
  v_sub_f32 v225, v225, v5
  v_sub_f32 v226, v226, v5
  v_sub_f32 v227, v227, v5
  v_sub_f32 v228, v228, v5
  v_sub_f32 v229, v229, v5
  v_mul_f32 v218, s36, v218
  v_mul_f32 v219, s36, v219
  v_mul_f32 v220, s36, v220
  v_mul_f32 v221, s36, v221
  v_mul_f32 v222, s36, v222
  v_mul_f32 v223, s36, v223
  v_mul_f32 v224, s36, v224
  v_mul_f32 v225, s36, v225
  v_mul_f32 v226, s36, v226
  v_mul_f32 v227, s36, v227
  v_mul_f32 v228, s36, v228
  v_mul_f32 v229, s36, v229
  v_exp_f32 v218, v218
  v_exp_f32 v219, v219
  v_exp_f32 v220, v220
  v_exp_f32 v221, v221
  v_exp_f32 v222, v222
  v_exp_f32 v223, v223
  v_exp_f32 v224, v224
  v_exp_f32 v225, v225
  v_exp_f32 v226, v226
  v_exp_f32 v227, v227
  v_exp_f32 v228, v228
  v_exp_f32 v229, v229
  v_add_f32 v4, v218, v219
  v_add_f32 v4, v4, v220
  v_add_f32 v4, v4, v221
  v_add_f32 v4, v4, v222
  v_add_f32 v4, v4, v223
  v_add_f32 v4, v4, v224
  v_add_f32 v4, v4, v225
  v_add_f32 v4, v4, v226
  v_add_f32 v4, v4, v227
  v_add_f32 v4, v4, v228
  v_add_f32 v4, v4, v229
  v_cvt_pk_bf16_f32 v218, v218, v218
  v_cvt_pk_bf16_f32 v219, v219, v219
  v_cvt_pk_bf16_f32 v220, v220, v220
  v_cvt_pk_bf16_f32 v221, v221, v221
  v_cvt_pk_bf16_f32 v222, v222, v222
  v_cvt_pk_bf16_f32 v223, v223, v223
  v_cvt_pk_bf16_f32 v224, v224, v224
  v_cvt_pk_bf16_f32 v225, v225, v225
  v_cvt_pk_bf16_f32 v226, v226, v226
  v_cvt_pk_bf16_f32 v227, v227, v227
  v_cvt_pk_bf16_f32 v228, v228, v228
  v_cvt_pk_bf16_f32 v229, v229, v229
  s_mov_b32 s37, 2
L_vl:
  s_waitcnt vmcnt(4)
  v_and_b32_dpp v28, v218, v10 row_newbcast:0 row_mask:0xf bank_mask:0xf
  v_and_b32_dpp v29, v218, v11 row_newbcast:0 row_mask:0xf bank_mask:0xf
  v_and_b32_dpp v30, v218, v12 row_newbcast:0 row_mask:0xf bank_mask:0xf
  v_and_b32_dpp v31, v218, v13 row_newbcast:0 row_mask:0xf bank_mask:0xf
  s_nop 1
  v_mfma_f32_16x16x32_bf16 v[20:23], v[68:71], v[28:31], v[20:23]
  v_mfma_f32_16x16x32_bf16 v[24:27], v[72:75], v[28:31], v[24:27]
  v_and_b32_dpp v32, v218, v10 row_newbcast:4 row_mask:0xf bank_mask:0xf
  v_and_b32_dpp v33, v218, v11 row_newbcast:4 row_mask:0xf bank_mask:0xf
  v_and_b32_dpp v34, v218, v12 row_newbcast:4 row_mask:0xf bank_mask:0xf
  v_and_b32_dpp v35, v218, v13 row_newbcast:4 row_mask:0xf bank_mask:0xf
  s_nop 1
  v_mfma_f32_16x16x32_bf16 v[20:23], v[76:79], v[32:35], v[20:23]
  v_mfma_f32_16x16x32_bf16 v[24:27], v[80:83], v[32:35], v[24:27]
  v_and_b32_dpp v28, v218, v10 row_newbcast:8 row_mask:0xf bank_mask:0xf
  v_and_b32_dpp v29, v218, v11 row_newbcast:8 row_mask:0xf bank_mask:0xf
  v_and_b32_dpp v30, v218, v12 row_newbcast:8 row_mask:0xf bank_mask:0xf
  v_and_b32_dpp v31, v218, v13 row_newbcast:8 row_mask:0xf bank_mask:0xf
  s_nop 1
  v_mfma_f32_16x16x32_bf16 v[20:23], v[84:87], v[28:31], v[20:23]
  v_mfma_f32_16x16x32_bf16 v[24:27], v[88:91], v[28:31], v[24:27]
  v_and_b32_dpp v32, v218, v10 row_newbcast:12 row_mask:0xf bank_mask:0xf
  v_and_b32_dpp v33, v218, v11 row_newbcast:12 row_mask:0xf bank_mask:0xf
  v_and_b32_dpp v34, v218, v12 row_newbcast:12 row_mask:0xf bank_mask:0xf
  v_and_b32_dpp v35, v218, v13 row_newbcast:12 row_mask:0xf bank_mask:0xf
  s_nop 1
  v_mfma_f32_16x16x32_bf16 v[20:23], v[92:95], v[32:35], v[20:23]
  v_mfma_f32_16x16x32_bf16 v[24:27], v[96:99], v[32:35], v[24:27]
  buffer_load_dwordx4 v[68:71], v3, s[12:15], s21 offen offset:0 nt
  buffer_load_dwordx4 v[72:75], v3, s[12:15], s21 offen offset:256 nt
  buffer_load_dwordx4 v[76:79], v3, s[12:15], s21 offen offset:2048 nt
  buffer_load_dwordx4 v[80:83], v3, s[12:15], s21 offen offset:2304 nt
  s_add_u32 s21, s21, 65536
  s_waitcnt vmcnt(4)
  buffer_load_dwordx4 v[84:87], v3, s[12:15], s21 offen offset:0 nt
  buffer_load_dwordx4 v[88:91], v3, s[12:15], s21 offen offset:256 nt
  buffer_load_dwordx4 v[92:95], v3, s[12:15], s21 offen offset:2048 nt
  buffer_load_dwordx4 v[96:99], v3, s[12:15], s21 offen offset:2304 nt
  s_add_u32 s21, s21, 65536
  s_waitcnt vmcnt(4)
  v_and_b32_dpp v28, v219, v10 row_newbcast:0 row_mask:0xf bank_mask:0xf
  v_and_b32_dpp v29, v219, v11 row_newbcast:0 row_mask:0xf bank_mask:0xf
  v_and_b32_dpp v30, v219, v12 row_newbcast:0 row_mask:0xf bank_mask:0xf
  v_and_b32_dpp v31, v219, v13 row_newbcast:0 row_mask:0xf bank_mask:0xf
  s_nop 1
  v_mfma_f32_16x16x32_bf16 v[20:23], v[100:103], v[28:31], v[20:23]
  v_mfma_f32_16x16x32_bf16 v[24:27], v[104:107], v[28:31], v[24:27]
  v_and_b32_dpp v32, v219, v10 row_newbcast:4 row_mask:0xf bank_mask:0xf
  v_and_b32_dpp v33, v219, v11 row_newbcast:4 row_mask:0xf bank_mask:0xf
  v_and_b32_dpp v34, v219, v12 row_newbcast:4 row_mask:0xf bank_mask:0xf
  v_and_b32_dpp v35, v219, v13 row_newbcast:4 row_mask:0xf bank_mask:0xf
  s_nop 1
  v_mfma_f32_16x16x32_bf16 v[20:23], v[108:111], v[32:35], v[20:23]
  v_mfma_f32_16x16x32_bf16 v[24:27], v[112:115], v[32:35], v[24:27]
  v_and_b32_dpp v28, v219, v10 row_newbcast:8 row_mask:0xf bank_mask:0xf
  v_and_b32_dpp v29, v219, v11 row_newbcast:8 row_mask:0xf bank_mask:0xf
  v_and_b32_dpp v30, v219, v12 row_newbcast:8 row_mask:0xf bank_mask:0xf
  v_and_b32_dpp v31, v219, v13 row_newbcast:8 row_mask:0xf bank_mask:0xf
  s_nop 1
  v_mfma_f32_16x16x32_bf16 v[20:23], v[116:119], v[28:31], v[20:23]
  v_mfma_f32_16x16x32_bf16 v[24:27], v[120:123], v[28:31], v[24:27]
  v_and_b32_dpp v32, v219, v10 row_newbcast:12 row_mask:0xf bank_mask:0xf
  v_and_b32_dpp v33, v219, v11 row_newbcast:12 row_mask:0xf bank_mask:0xf
  v_and_b32_dpp v34, v219, v12 row_newbcast:12 row_mask:0xf bank_mask:0xf
  v_and_b32_dpp v35, v219, v13 row_newbcast:12 row_mask:0xf bank_mask:0xf
  s_nop 1
  v_mfma_f32_16x16x32_bf16 v[20:23], v[124:127], v[32:35], v[20:23]
  v_mfma_f32_16x16x32_bf16 v[24:27], v[128:131], v[32:35], v[24:27]
  buffer_load_dwordx4 v[100:103], v3, s[12:15], s21 offen offset:0 nt
  buffer_load_dwordx4 v[104:107], v3, s[12:15], s21 offen offset:256 nt
  buffer_load_dwordx4 v[108:111], v3, s[12:15], s21 offen offset:2048 nt
  buffer_load_dwordx4 v[112:115], v3, s[12:15], s21 offen offset:2304 nt
  s_add_u32 s21, s21, 65536
  s_waitcnt vmcnt(4)
  buffer_load_dwordx4 v[116:119], v3, s[12:15], s21 offen offset:0 nt
  buffer_load_dwordx4 v[120:123], v3, s[12:15], s21 offen offset:256 nt
  buffer_load_dwordx4 v[124:127], v3, s[12:15], s21 offen offset:2048 nt
  buffer_load_dwordx4 v[128:131], v3, s[12:15], s21 offen offset:2304 nt
  s_add_u32 s21, s21, 65536
  s_waitcnt vmcnt(4)
  v_and_b32_dpp v28, v220, v10 row_newbcast:0 row_mask:0xf bank_mask:0xf
  v_and_b32_dpp v29, v220, v11 row_newbcast:0 row_mask:0xf bank_mask:0xf
  v_and_b32_dpp v30, v220, v12 row_newbcast:0 row_mask:0xf bank_mask:0xf
  v_and_b32_dpp v31, v220, v13 row_newbcast:0 row_mask:0xf bank_mask:0xf
  s_nop 1
  v_mfma_f32_16x16x32_bf16 v[20:23], v[132:135], v[28:31], v[20:23]
  v_mfma_f32_16x16x32_bf16 v[24:27], v[136:139], v[28:31], v[24:27]
  v_and_b32_dpp v32, v220, v10 row_newbcast:4 row_mask:0xf bank_mask:0xf
  v_and_b32_dpp v33, v220, v11 row_newbcast:4 row_mask:0xf bank_mask:0xf
  v_and_b32_dpp v34, v220, v12 row_newbcast:4 row_mask:0xf bank_mask:0xf
  v_and_b32_dpp v35, v220, v13 row_newbcast:4 row_mask:0xf bank_mask:0xf
  s_nop 1
  v_mfma_f32_16x16x32_bf16 v[20:23], v[140:143], v[32:35], v[20:23]
  v_mfma_f32_16x16x32_bf16 v[24:27], v[144:147], v[32:35], v[24:27]
  v_and_b32_dpp v28, v220, v10 row_newbcast:8 row_mask:0xf bank_mask:0xf
  v_and_b32_dpp v29, v220, v11 row_newbcast:8 row_mask:0xf bank_mask:0xf
  v_and_b32_dpp v30, v220, v12 row_newbcast:8 row_mask:0xf bank_mask:0xf
  v_and_b32_dpp v31, v220, v13 row_newbcast:8 row_mask:0xf bank_mask:0xf
  s_nop 1
  v_mfma_f32_16x16x32_bf16 v[20:23], v[148:151], v[28:31], v[20:23]
  v_mfma_f32_16x16x32_bf16 v[24:27], v[152:155], v[28:31], v[24:27]
  v_and_b32_dpp v32, v220, v10 row_newbcast:12 row_mask:0xf bank_mask:0xf
  v_and_b32_dpp v33, v220, v11 row_newbcast:12 row_mask:0xf bank_mask:0xf
  v_and_b32_dpp v34, v220, v12 row_newbcast:12 row_mask:0xf bank_mask:0xf
  v_and_b32_dpp v35, v220, v13 row_newbcast:12 row_mask:0xf bank_mask:0xf
  s_nop 1
  v_mfma_f32_16x16x32_bf16 v[20:23], v[156:159], v[32:35], v[20:23]
  v_mfma_f32_16x16x32_bf16 v[24:27], v[160:163], v[32:35], v[24:27]
  buffer_load_dwordx4 v[132:135], v3, s[12:15], s21 offen offset:0 nt
  buffer_load_dwordx4 v[136:139], v3, s[12:15], s21 offen offset:256 nt
  buffer_load_dwordx4 v[140:143], v3, s[12:15], s21 offen offset:2048 nt
  buffer_load_dwordx4 v[144:147], v3, s[12:15], s21 offen offset:2304 nt
  s_add_u32 s21, s21, 65536
  s_waitcnt vmcnt(4)
  buffer_load_dwordx4 v[148:151], v3, s[12:15], s21 offen offset:0 nt
  buffer_load_dwordx4 v[152:155], v3, s[12:15], s21 offen offset:256 nt
  buffer_load_dwordx4 v[156:159], v3, s[12:15], s21 offen offset:2048 nt
  buffer_load_dwordx4 v[160:163], v3, s[12:15], s21 offen offset:2304 nt
  s_add_u32 s21, s21, 65536
  s_waitcnt vmcnt(4)
  v_and_b32_dpp v28, v221, v10 row_newbcast:0 row_mask:0xf bank_mask:0xf
  v_and_b32_dpp v29, v221, v11 row_newbcast:0 row_mask:0xf bank_mask:0xf
  v_and_b32_dpp v30, v221, v12 row_newbcast:0 row_mask:0xf bank_mask:0xf
  v_and_b32_dpp v31, v221, v13 row_newbcast:0 row_mask:0xf bank_mask:0xf
  s_nop 1
  v_mfma_f32_16x16x32_bf16 v[20:23], v[164:167], v[28:31], v[20:23]
  v_mfma_f32_16x16x32_bf16 v[24:27], v[168:171], v[28:31], v[24:27]
  v_and_b32_dpp v32, v221, v10 row_newbcast:4 row_mask:0xf bank_mask:0xf
  v_and_b32_dpp v33, v221, v11 row_newbcast:4 row_mask:0xf bank_mask:0xf
  v_and_b32_dpp v34, v221, v12 row_newbcast:4 row_mask:0xf bank_mask:0xf
  v_and_b32_dpp v35, v221, v13 row_newbcast:4 row_mask:0xf bank_mask:0xf
  s_nop 1
  v_mfma_f32_16x16x32_bf16 v[20:23], v[172:175], v[32:35], v[20:23]
  v_mfma_f32_16x16x32_bf16 v[24:27], v[176:179], v[32:35], v[24:27]
  v_and_b32_dpp v28, v221, v10 row_newbcast:8 row_mask:0xf bank_mask:0xf
  v_and_b32_dpp v29, v221, v11 row_newbcast:8 row_mask:0xf bank_mask:0xf
  v_and_b32_dpp v30, v221, v12 row_newbcast:8 row_mask:0xf bank_mask:0xf
  v_and_b32_dpp v31, v221, v13 row_newbcast:8 row_mask:0xf bank_mask:0xf
  s_nop 1
  v_mfma_f32_16x16x32_bf16 v[20:23], v[180:183], v[28:31], v[20:23]
  v_mfma_f32_16x16x32_bf16 v[24:27], v[184:187], v[28:31], v[24:27]
  v_and_b32_dpp v32, v221, v10 row_newbcast:12 row_mask:0xf bank_mask:0xf
  v_and_b32_dpp v33, v221, v11 row_newbcast:12 row_mask:0xf bank_mask:0xf
  v_and_b32_dpp v34, v221, v12 row_newbcast:12 row_mask:0xf bank_mask:0xf
  v_and_b32_dpp v35, v221, v13 row_newbcast:12 row_mask:0xf bank_mask:0xf
  s_nop 1
  v_mfma_f32_16x16x32_bf16 v[20:23], v[188:191], v[32:35], v[20:23]
  v_mfma_f32_16x16x32_bf16 v[24:27], v[192:195], v[32:35], v[24:27]
  buffer_load_dwordx4 v[164:167], v3, s[12:15], s21 offen offset:0 nt
  buffer_load_dwordx4 v[168:171], v3, s[12:15], s21 offen offset:256 nt
  buffer_load_dwordx4 v[172:175], v3, s[12:15], s21 offen offset:2048 nt
  buffer_load_dwordx4 v[176:179], v3, s[12:15], s21 offen offset:2304 nt
  s_add_u32 s21, s21, 65536
  s_waitcnt vmcnt(4)
  buffer_load_dwordx4 v[180:183], v3, s[12:15], s21 offen offset:0 nt
  buffer_load_dwordx4 v[184:187], v3, s[12:15], s21 offen offset:256 nt
  buffer_load_dwordx4 v[188:191], v3, s[12:15], s21 offen offset:2048 nt
  buffer_load_dwordx4 v[192:195], v3, s[12:15], s21 offen offset:2304 nt
  s_add_u32 s21, s21, 65536
  v_mov_b32 v218, v222
  v_mov_b32 v219, v223
  v_mov_b32 v220, v224
  v_mov_b32 v221, v225
  v_mov_b32 v222, v226
  v_mov_b32 v223, v227
  v_mov_b32 v224, v228
  v_mov_b32 v225, v229
  s_sub_u32 s37, s37, 1
  s_cmp_eq_u32 s37, 0
  s_cbranch_scc1 L_ve
  s_branch L_vl
L_ve:
L_ver:
  v_bitop3_b32 v209, v204, v205, s72 bitop3:0x7e
  v_bitop3_b32 v210, v206, v207, s72 bitop3:0x7e
  v_bitop3_b32 v209, v209, v210, s68 bitop3:0xa8
  v_cmp_ne_u32 vcc, 0, v209
  s_cbranch_vccz L_verok
  s_sub_u32 s43, s43, 1
  s_cbranch_scc1 L_verok
  buffer_load_dwordx4 v[204:207], v208, s[16:19], 0 offen sc1
  s_waitcnt vmcnt(0)
  s_branch L_ver
L_verok:
  v_mov_b32 v244, 0
  v_mov_b32 v245, 0
  v_mov_b32 v246, 0
  v_mov_b32 v247, 0
  s_branch L_tchC
L_tchCr:
  s_branch L_tchE
L_tchEr:
  s_cmp_lg_u32 s74, 0
  s_cbranch_scc1 L_wskip
L_wret:
  v_lshrrev_b32 v244, 1, v1
  v_and_b32 v245, 1, v1
  v_lshlrev_b32 v245, 4, v245
  s_movk_i32 s22, 896
  v_mad_u32_u24 v244, v244, s22, v245
  s_lshl_b32 s22, s75, 2
  s_add_u32 s22, s22, s4
  s_mul_i32 s22, s22, 229376
  s_lshl_b32 s23, s73, 5
  s_add_u32 s22, s22, s23
  s_lshl_b32 s23, s4, 13
  s_add_u32 s23, s23, 5376
  s_mov_b32 s24, 4
  s_mov_b32 s5, 7
  s_mov_b64 s[68:69], 0
  s_mov_b64 exec, 0
  s_branch L_wq
L_wqret:
  s_mov_b64 s[68:69], -1
  s_mov_b64 exec, -1
  s_bfe_u32 s24, s2, 0x20003
  s_mul_i32 s24, s24, 4
  s_lshr_b32 s24, s24, 2
  s_add_u32 s24, s24, 4
L_wskip:
  s_cmp_lg_u32 s74, 1
  s_cbranch_scc1 L_fskip
  s_mov_b32 s78, 1605632
  s_mov_b32 s80, s64
  s_mov_b32 s81, s65
  s_mov_b32 s82, 1605632
  v_lshrrev_b32 v248, 1, v1
  v_and_b32 v249, 1, v1
  v_lshlrev_b32 v249, 4, v249
  s_movk_i32 s22, 3584
  v_mad_u32_u24 v248, v248, s22, v249
  s_lshl_b32 s58, s4, 2
  s_min_u32 s58, s58, 11
  s_cmp_lt_u32 s4, 2
  s_cselect_b32 s26, 4, 3
  s_bfe_u32 s6, s2, 0x20003
  s_cmp_ge_u32 s6, s26
  s_cselect_b32 s6, 0, s6
  s_lshl_b32 s7, s75, 5
  s_add_u32 s5, s6, s58
  s_mul_i32 s38, s5, 114688
  s_add_u32 s38, s38, s7
  s_lshl_b32 s5, s5, 10
  s_add_u32 s22, s5, 5376
  v_add_u32 v244, s38, v248
  s_add_u32 s6, s6, 1
  s_cmp_eq_u32 s6, s26
  s_cselect_b32 s6, 0, s6
  s_add_u32 s5, s6, s58
  s_mul_i32 s38, s5, 114688
  s_add_u32 s38, s38, s7
  s_lshl_b32 s5, s5, 10
  s_add_u32 s23, s5, 5376
  v_add_u32 v245, s38, v248
  s_add_u32 s6, s6, 1
  s_cmp_eq_u32 s6, s26
  s_cselect_b32 s6, 0, s6
  s_add_u32 s5, s6, s58
  s_mul_i32 s38, s5, 114688
  s_add_u32 s38, s38, s7
  s_lshl_b32 s5, s5, 10
  s_add_u32 s24, s5, 5376
  v_add_u32 v246, s38, v248
  s_add_u32 s6, s6, 1
  s_cmp_eq_u32 s6, s26
  s_cselect_b32 s6, 0, s6
  s_add_u32 s5, s6, s58
  s_mul_i32 s38, s5, 114688
  s_add_u32 s38, s38, s7
  s_lshl_b32 s5, s5, 10
  s_add_u32 s25, s5, 5376
  s_cmp_lt_u32 s4, 2
  s_cselect_b32 s38, s38, 0x40000000
  s_cselect_b32 s25, s25, 48384
  v_add_u32 v247, s38, v248
  s_add_u32 s6, s6, 1
  s_cmp_eq_u32 s6, s26
  s_cselect_b32 s6, 0, s6
L_firet:
L_fret:
L_fskip:
  v_and_b32 v254, 15, v1
  v_lshrrev_b32 v253, 4, v1
  v_lshlrev_b32 v253, 7, v253
  v_lshl_add_u32 v253, v254, 2, v253
  s_lshl_b32 s6, s4, 10
  v_add_u32 v253, s6, v253
  v_lshrrev_b32 v255, 3, v1
  v_lshlrev_b32 v255, 7, v255
  v_and_b32 v254, 1, v1
  v_lshl_add_u32 v255, v254, 6, v255
  v_bfe_u32 v254, v1, 1, 2
  v_lshl_add_u32 v255, v254, 4, v255
  s_lshl_b32 s6, s4, 3
  v_mov_b32 v254, s6
  s_and_b32 s5, s2, 3
  s_lshl_b32 s5, s5, 2
  s_lshr_b32 s6, s2, 6
  s_add_u32 s5, s5, s6
  s_bfe_u32 s7, s2, 0x40002
  s_mul_i32 s7, s7, 10240
  s_add_u32 s7, s7, 266240
  s_lshl_b32 s6, s5, 9
  s_add_u32 s6, s6, s7
  s_lshl_b32 s5, s5, 7
  s_add_u32 s7, s7, s5
  s_add_u32 s7, s7, 8192
  s_lshl_b32 s5, s75, 2
  s_add_u32 s5, s5, s4
  s_mul_i32 s26, s5, 10240
  s_add_u32 s26, s26, 266240
  s_add_u32 s56, s26, 4096
  s_add_u32 s59, s26, 8192
  s_mov_b64 exec, 1
  ds_add_rtn_u32 v233, v231, v232 offset:40960
  s_waitcnt lgkmcnt(0)
  v_and_b32 v234, -4, v233
  v_readfirstlane_b32 s5, v233
L_sp_4:
  ds_read_b32 v233, v234 offset:41024
  s_waitcnt lgkmcnt(0)
  v_readfirstlane_b32 s27, v233
  s_cmp_lg_u32 s27, -1
  s_cbranch_scc1 L_sq_5
  s_sub_u32 s43, s43, 1
  s_cbranch_scc1 L_sq_5
  s_branch L_sp_4
L_sq_5:
  s_mov_b64 exec, -1
  s_min_u32 s27, s27, 128
  s_and_b32 s38, s5, 3
  s_lshl2_add_u32 s27, s27, s38
  s_cmp_lg_u32 s38, 3
  s_cbranch_scc1 L_nr_6
  s_cmp_ge_u32 s27, 128
  s_cbranch_scc1 L_nr_6
  s_lshr_b32 s55, s5, 2
  s_lshl2_add_u32 s55, s55, 4
  s_mov_b32 s54, 1
  s_atomic_add s54, s[40:41], 0 glc
L_nr_6:
  s_waitcnt vmcnt(24)
  v_and_b32_dpp v28, v218, v10 row_newbcast:0 row_mask:0xf bank_mask:0xf
  v_and_b32_dpp v29, v218, v11 row_newbcast:0 row_mask:0xf bank_mask:0xf
  v_and_b32_dpp v30, v218, v12 row_newbcast:0 row_mask:0xf bank_mask:0xf
  v_and_b32_dpp v31, v218, v13 row_newbcast:0 row_mask:0xf bank_mask:0xf
  s_nop 1
  v_mfma_f32_16x16x32_bf16 v[20:23], v[68:71], v[28:31], v[20:23]
  v_mfma_f32_16x16x32_bf16 v[24:27], v[72:75], v[28:31], v[24:27]
  v_and_b32_dpp v32, v218, v10 row_newbcast:4 row_mask:0xf bank_mask:0xf
  v_and_b32_dpp v33, v218, v11 row_newbcast:4 row_mask:0xf bank_mask:0xf
  v_and_b32_dpp v34, v218, v12 row_newbcast:4 row_mask:0xf bank_mask:0xf
  v_and_b32_dpp v35, v218, v13 row_newbcast:4 row_mask:0xf bank_mask:0xf
  s_nop 1
  v_mfma_f32_16x16x32_bf16 v[20:23], v[76:79], v[32:35], v[20:23]
  v_mfma_f32_16x16x32_bf16 v[24:27], v[80:83], v[32:35], v[24:27]
  v_and_b32_dpp v28, v218, v10 row_newbcast:8 row_mask:0xf bank_mask:0xf
  v_and_b32_dpp v29, v218, v11 row_newbcast:8 row_mask:0xf bank_mask:0xf
  v_and_b32_dpp v30, v218, v12 row_newbcast:8 row_mask:0xf bank_mask:0xf
  v_and_b32_dpp v31, v218, v13 row_newbcast:8 row_mask:0xf bank_mask:0xf
  s_nop 1
  v_mfma_f32_16x16x32_bf16 v[20:23], v[84:87], v[28:31], v[20:23]
  v_mfma_f32_16x16x32_bf16 v[24:27], v[88:91], v[28:31], v[24:27]
  v_and_b32_dpp v32, v218, v10 row_newbcast:12 row_mask:0xf bank_mask:0xf
  v_and_b32_dpp v33, v218, v11 row_newbcast:12 row_mask:0xf bank_mask:0xf
  v_and_b32_dpp v34, v218, v12 row_newbcast:12 row_mask:0xf bank_mask:0xf
  v_and_b32_dpp v35, v218, v13 row_newbcast:12 row_mask:0xf bank_mask:0xf
  s_nop 1
  v_mfma_f32_16x16x32_bf16 v[20:23], v[92:95], v[32:35], v[20:23]
  v_mfma_f32_16x16x32_bf16 v[24:27], v[96:99], v[32:35], v[24:27]
  s_add_u32 s20, s27, 384
  s_cmp_ge_u32 s20, 512
  s_cbranch_scc1 L_dA
  s_lshl_b32 s20, s20, 12
  s_add_u32 s20, s20, s3
  s_mov_b32 s21, s20
  buffer_load_dwordx4 v[68:71], v2, s[8:11], s20 offen offset:0 nt
  buffer_load_dwordx4 v[72:75], v2, s[8:11], s20 offen offset:256 nt
  buffer_load_dwordx4 v[76:79], v2, s[8:11], s20 offen offset:2048 nt
  buffer_load_dwordx4 v[80:83], v2, s[8:11], s20 offen offset:2304 nt
  s_add_u32 s20, s20, 65536
  s_waitcnt vmcnt(20)
  v_and_b32_dpp v28, v219, v10 row_newbcast:0 row_mask:0xf bank_mask:0xf
  v_and_b32_dpp v29, v219, v11 row_newbcast:0 row_mask:0xf bank_mask:0xf
  v_and_b32_dpp v30, v219, v12 row_newbcast:0 row_mask:0xf bank_mask:0xf
  v_and_b32_dpp v31, v219, v13 row_newbcast:0 row_mask:0xf bank_mask:0xf
  s_nop 1
  v_mfma_f32_16x16x32_bf16 v[20:23], v[100:103], v[28:31], v[20:23]
  v_mfma_f32_16x16x32_bf16 v[24:27], v[104:107], v[28:31], v[24:27]
  v_and_b32_dpp v32, v219, v10 row_newbcast:4 row_mask:0xf bank_mask:0xf
  v_and_b32_dpp v33, v219, v11 row_newbcast:4 row_mask:0xf bank_mask:0xf
  v_and_b32_dpp v34, v219, v12 row_newbcast:4 row_mask:0xf bank_mask:0xf
  v_and_b32_dpp v35, v219, v13 row_newbcast:4 row_mask:0xf bank_mask:0xf
  s_nop 1
  v_mfma_f32_16x16x32_bf16 v[20:23], v[108:111], v[32:35], v[20:23]
  v_mfma_f32_16x16x32_bf16 v[24:27], v[112:115], v[32:35], v[24:27]
  v_and_b32_dpp v28, v219, v10 row_newbcast:8 row_mask:0xf bank_mask:0xf
  v_and_b32_dpp v29, v219, v11 row_newbcast:8 row_mask:0xf bank_mask:0xf
  v_and_b32_dpp v30, v219, v12 row_newbcast:8 row_mask:0xf bank_mask:0xf
  v_and_b32_dpp v31, v219, v13 row_newbcast:8 row_mask:0xf bank_mask:0xf
  s_nop 1
  v_mfma_f32_16x16x32_bf16 v[20:23], v[116:119], v[28:31], v[20:23]
  v_mfma_f32_16x16x32_bf16 v[24:27], v[120:123], v[28:31], v[24:27]
  v_and_b32_dpp v32, v219, v10 row_newbcast:12 row_mask:0xf bank_mask:0xf
  v_and_b32_dpp v33, v219, v11 row_newbcast:12 row_mask:0xf bank_mask:0xf
  v_and_b32_dpp v34, v219, v12 row_newbcast:12 row_mask:0xf bank_mask:0xf
  v_and_b32_dpp v35, v219, v13 row_newbcast:12 row_mask:0xf bank_mask:0xf
  s_nop 1
  v_mfma_f32_16x16x32_bf16 v[20:23], v[124:127], v[32:35], v[20:23]
  v_mfma_f32_16x16x32_bf16 v[24:27], v[128:131], v[32:35], v[24:27]
  buffer_load_dwordx4 v[100:103], v3, s[12:15], s21 offen offset:0 nt
  buffer_load_dwordx4 v[104:107], v3, s[12:15], s21 offen offset:256 nt
  buffer_load_dwordx4 v[108:111], v3, s[12:15], s21 offen offset:2048 nt
  buffer_load_dwordx4 v[112:115], v3, s[12:15], s21 offen offset:2304 nt
  s_add_u32 s21, s21, 65536
  s_cmp_eq_u32 s55, -1
  s_cbranch_scc1 L_np_7
  s_waitcnt lgkmcnt(0)
  s_add_u32 s54, s54, 4
  v_mov_b32 v233, s55
  v_mov_b32 v234, s54
  s_mov_b64 exec, 1
  ds_write_b32 v233, v234 offset:41024
  s_mov_b64 exec, -1
  s_mov_b32 s55, -1
L_np_7:
  s_mov_b64 exec, 1
  ds_add_rtn_u32 v233, v231, v232 offset:40960
  s_waitcnt lgkmcnt(0)
  v_and_b32 v234, -4, v233
  v_readfirstlane_b32 s5, v233
L_sp_8:
  ds_read_b32 v233, v234 offset:41024
  s_waitcnt lgkmcnt(0)
  v_readfirstlane_b32 s27, v233
  s_cmp_lg_u32 s27, -1
  s_cbranch_scc1 L_sq_9
  s_sub_u32 s43, s43, 1
  s_cbranch_scc1 L_sq_9
  s_branch L_sp_8
L_sq_9:
  s_mov_b64 exec, -1
  s_min_u32 s27, s27, 128
  s_and_b32 s38, s5, 3
  s_lshl2_add_u32 s27, s27, s38
  s_cmp_lg_u32 s38, 3
  s_cbranch_scc1 L_nr_10
  s_cmp_ge_u32 s27, 128
  s_cbranch_scc1 L_nr_10
  s_lshr_b32 s55, s5, 2
  s_lshl2_add_u32 s55, s55, 4
  s_mov_b32 s54, 1
  s_atomic_add s54, s[40:41], 0 glc
L_nr_10:
  s_waitcnt vmcnt(16)
  v_and_b32_dpp v28, v220, v10 row_newbcast:0 row_mask:0xf bank_mask:0xf
  v_and_b32_dpp v29, v220, v11 row_newbcast:0 row_mask:0xf bank_mask:0xf
  v_and_b32_dpp v30, v220, v12 row_newbcast:0 row_mask:0xf bank_mask:0xf
  v_and_b32_dpp v31, v220, v13 row_newbcast:0 row_mask:0xf bank_mask:0xf
  s_nop 1
  v_mfma_f32_16x16x32_bf16 v[20:23], v[132:135], v[28:31], v[20:23]
  v_mfma_f32_16x16x32_bf16 v[24:27], v[136:139], v[28:31], v[24:27]
  v_and_b32_dpp v32, v220, v10 row_newbcast:4 row_mask:0xf bank_mask:0xf
  v_and_b32_dpp v33, v220, v11 row_newbcast:4 row_mask:0xf bank_mask:0xf
  v_and_b32_dpp v34, v220, v12 row_newbcast:4 row_mask:0xf bank_mask:0xf
  v_and_b32_dpp v35, v220, v13 row_newbcast:4 row_mask:0xf bank_mask:0xf
  s_nop 1
  v_mfma_f32_16x16x32_bf16 v[20:23], v[140:143], v[32:35], v[20:23]
  v_mfma_f32_16x16x32_bf16 v[24:27], v[144:147], v[32:35], v[24:27]
  v_and_b32_dpp v28, v220, v10 row_newbcast:8 row_mask:0xf bank_mask:0xf
  v_and_b32_dpp v29, v220, v11 row_newbcast:8 row_mask:0xf bank_mask:0xf
  v_and_b32_dpp v30, v220, v12 row_newbcast:8 row_mask:0xf bank_mask:0xf
  v_and_b32_dpp v31, v220, v13 row_newbcast:8 row_mask:0xf bank_mask:0xf
  s_nop 1
  v_mfma_f32_16x16x32_bf16 v[20:23], v[148:151], v[28:31], v[20:23]
  v_mfma_f32_16x16x32_bf16 v[24:27], v[152:155], v[28:31], v[24:27]
  v_and_b32_dpp v32, v220, v10 row_newbcast:12 row_mask:0xf bank_mask:0xf
  v_and_b32_dpp v33, v220, v11 row_newbcast:12 row_mask:0xf bank_mask:0xf
  v_and_b32_dpp v34, v220, v12 row_newbcast:12 row_mask:0xf bank_mask:0xf
  v_and_b32_dpp v35, v220, v13 row_newbcast:12 row_mask:0xf bank_mask:0xf
  s_nop 1
  v_mfma_f32_16x16x32_bf16 v[20:23], v[156:159], v[32:35], v[20:23]
  v_mfma_f32_16x16x32_bf16 v[24:27], v[160:163], v[32:35], v[24:27]
  s_add_u32 s20, s27, 384
  s_cmp_ge_u32 s20, 512
  s_cbranch_scc1 L_dB
  s_lshl_b32 s20, s20, 12
  s_add_u32 s20, s20, s3
  s_mov_b32 s21, s20
  buffer_load_dwordx4 v[132:135], v2, s[8:11], s20 offen offset:0 nt
  buffer_load_dwordx4 v[136:139], v2, s[8:11], s20 offen offset:256 nt
  buffer_load_dwordx4 v[140:143], v2, s[8:11], s20 offen offset:2048 nt
  buffer_load_dwordx4 v[144:147], v2, s[8:11], s20 offen offset:2304 nt
  s_add_u32 s20, s20, 65536
  s_waitcnt vmcnt(12)
  v_and_b32_dpp v28, v221, v10 row_newbcast:0 row_mask:0xf bank_mask:0xf
  v_and_b32_dpp v29, v221, v11 row_newbcast:0 row_mask:0xf bank_mask:0xf
  v_and_b32_dpp v30, v221, v12 row_newbcast:0 row_mask:0xf bank_mask:0xf
  v_and_b32_dpp v31, v221, v13 row_newbcast:0 row_mask:0xf bank_mask:0xf
  s_nop 1
  v_mfma_f32_16x16x32_bf16 v[20:23], v[164:167], v[28:31], v[20:23]
  v_mfma_f32_16x16x32_bf16 v[24:27], v[168:171], v[28:31], v[24:27]
  v_and_b32_dpp v32, v221, v10 row_newbcast:4 row_mask:0xf bank_mask:0xf
  v_and_b32_dpp v33, v221, v11 row_newbcast:4 row_mask:0xf bank_mask:0xf
  v_and_b32_dpp v34, v221, v12 row_newbcast:4 row_mask:0xf bank_mask:0xf
  v_and_b32_dpp v35, v221, v13 row_newbcast:4 row_mask:0xf bank_mask:0xf
  s_nop 1
  v_mfma_f32_16x16x32_bf16 v[20:23], v[172:175], v[32:35], v[20:23]
  v_mfma_f32_16x16x32_bf16 v[24:27], v[176:179], v[32:35], v[24:27]
  v_and_b32_dpp v28, v221, v10 row_newbcast:8 row_mask:0xf bank_mask:0xf
  v_and_b32_dpp v29, v221, v11 row_newbcast:8 row_mask:0xf bank_mask:0xf
  v_and_b32_dpp v30, v221, v12 row_newbcast:8 row_mask:0xf bank_mask:0xf
  v_and_b32_dpp v31, v221, v13 row_newbcast:8 row_mask:0xf bank_mask:0xf
  s_nop 1
  v_mfma_f32_16x16x32_bf16 v[20:23], v[180:183], v[28:31], v[20:23]
  v_mfma_f32_16x16x32_bf16 v[24:27], v[184:187], v[28:31], v[24:27]
  v_and_b32_dpp v32, v221, v10 row_newbcast:12 row_mask:0xf bank_mask:0xf
  v_and_b32_dpp v33, v221, v11 row_newbcast:12 row_mask:0xf bank_mask:0xf
  v_and_b32_dpp v34, v221, v12 row_newbcast:12 row_mask:0xf bank_mask:0xf
  v_and_b32_dpp v35, v221, v13 row_newbcast:12 row_mask:0xf bank_mask:0xf
  s_nop 1
  v_mfma_f32_16x16x32_bf16 v[20:23], v[188:191], v[32:35], v[20:23]
  v_mfma_f32_16x16x32_bf16 v[24:27], v[192:195], v[32:35], v[24:27]
  buffer_load_dwordx4 v[164:167], v3, s[12:15], s21 offen offset:0 nt
  buffer_load_dwordx4 v[168:171], v3, s[12:15], s21 offen offset:256 nt
  buffer_load_dwordx4 v[172:175], v3, s[12:15], s21 offen offset:2048 nt
  buffer_load_dwordx4 v[176:179], v3, s[12:15], s21 offen offset:2304 nt
  s_add_u32 s21, s21, 65536
  s_cmp_eq_u32 s55, -1
  s_cbranch_scc1 L_np_11
  s_waitcnt lgkmcnt(0)
  s_add_u32 s54, s54, 4
  v_mov_b32 v233, s55
  v_mov_b32 v234, s54
  s_mov_b64 exec, 1
  ds_write_b32 v233, v234 offset:41024
  s_mov_b64 exec, -1
  s_mov_b32 s55, -1
L_np_11:
L_dl:
  s_mov_b64 exec, 1
  ds_add_rtn_u32 v233, v231, v232 offset:40960
  s_waitcnt lgkmcnt(0)
  v_and_b32 v234, -4, v233
  v_readfirstlane_b32 s5, v233
L_sp_12:
  ds_read_b32 v233, v234 offset:41024
  s_waitcnt lgkmcnt(0)
  v_readfirstlane_b32 s27, v233
  s_cmp_lg_u32 s27, -1
  s_cbranch_scc1 L_sq_13
  s_sub_u32 s43, s43, 1
  s_cbranch_scc1 L_sq_13
  s_branch L_sp_12
L_sq_13:
  s_mov_b64 exec, -1
  s_min_u32 s27, s27, 128
  s_and_b32 s38, s5, 3
  s_lshl2_add_u32 s27, s27, s38
  s_cmp_lg_u32 s38, 3
  s_cbranch_scc1 L_nr_14
  s_cmp_ge_u32 s27, 128
  s_cbranch_scc1 L_nr_14
  s_lshr_b32 s55, s5, 2
  s_lshl2_add_u32 s55, s55, 4
  s_mov_b32 s54, 1
  s_atomic_add s54, s[40:41], 0 glc
L_nr_14:
  s_waitcnt vmcnt(8)
  v_mfma_f32_16x16x32_bf16 v[16:19], v[68:71], v[36:39], 0
  v_mfma_f32_16x16x32_bf16 v[16:19], v[72:75], v[40:43], v[16:19]
  v_mfma_f32_16x16x32_bf16 v[16:19], v[76:79], v[44:47], v[16:19]
  v_mfma_f32_16x16x32_bf16 v[16:19], v[80:83], v[48:51], v[16:19]
  s_add_u32 s20, s27, 384
  s_cmp_ge_u32 s20, 512
  s_cbranch_scc1 L_dC
  s_lshl_b32 s20, s20, 12
  s_add_u32 s20, s20, s3
  s_mov_b32 s21, s20
  buffer_load_dwordx4 v[68:71], v2, s[8:11], s20 offen offset:0 nt
  buffer_load_dwordx4 v[72:75], v2, s[8:11], s20 offen offset:256 nt
  buffer_load_dwordx4 v[76:79], v2, s[8:11], s20 offen offset:2048 nt
  buffer_load_dwordx4 v[80:83], v2, s[8:11], s20 offen offset:2304 nt
  s_add_u32 s20, s20, 65536
  v_cndmask_b32 v6, v16, v17, s[30:31]
  v_cndmask_b32 v6, v6, v18, s[32:33]
  v_cndmask_b32 v6, v6, v19, s[34:35]
  s_nop 1
  v_add_f32_dpp v6, v6, v6 quad_perm:[1,0,3,2] row_mask:0xf bank_mask:0xf
  s_nop 1
  v_add_f32_dpp v6, v6, v6 quad_perm:[2,3,0,1] row_mask:0xf bank_mask:0xf
  v_cvt_pk_bf16_f32 v6, v6, v6
  v_and_b32 v6, 0xffff0000, v6
  v_cndmask_b32 v6, v6, v200, s[28:29]
  v_mov_b32 v8, v6
  s_nop 1
  v_max_f32_dpp v8, v8, v8 row_ror:4 row_mask:0xf bank_mask:0xf
  s_nop 1
  v_max_f32_dpp v8, v8, v8 row_ror:8 row_mask:0xf bank_mask:0xf
  s_nop 1
  v_max_f32_dpp v8, v8, v8 row_bcast:15 row_mask:0xa bank_mask:0xf
  s_nop 1
  v_max_f32_dpp v8, v8, v8 row_bcast:31 row_mask:0xc bank_mask:0xf
  s_nop 0
  v_readlane_b32 s38, v8, 63
  s_nop 1
  v_max_f32 v8, s38, v5
  v_sub_f32 v9, v5, v8
  v_sub_f32 v7, v6, v8
  v_mul_f32 v9, s36, v9
  v_mul_f32 v7, s36, v7
  v_exp_f32 v9, v9
  v_exp_f32 v7, v7
  v_mov_b32 v5, v8
  v_fma_f32 v4, v4, v9, v7
  v_cvt_pk_bf16_f32 v7, v7, v7
  v_mul_f32 v20, v20, v9
  v_mul_f32 v21, v21, v9
  v_mul_f32 v22, v22, v9
  v_mul_f32 v23, v23, v9
  v_mul_f32 v24, v24, v9
  v_mul_f32 v25, v25, v9
  v_mul_f32 v26, v26, v9
  v_mul_f32 v27, v27, v9
  s_waitcnt vmcnt(8)
  v_and_b32_dpp v28, v7, v10 row_newbcast:0 row_mask:0xf bank_mask:0xf
  v_and_b32_dpp v29, v7, v11 row_newbcast:0 row_mask:0xf bank_mask:0xf
  v_and_b32_dpp v30, v7, v12 row_newbcast:0 row_mask:0xf bank_mask:0xf
  v_and_b32_dpp v31, v7, v13 row_newbcast:0 row_mask:0xf bank_mask:0xf
  s_nop 1
  v_mfma_f32_16x16x32_bf16 v[20:23], v[100:103], v[28:31], v[20:23]
  v_mfma_f32_16x16x32_bf16 v[24:27], v[104:107], v[28:31], v[24:27]
  v_and_b32_dpp v32, v7, v10 row_newbcast:4 row_mask:0xf bank_mask:0xf
  v_and_b32_dpp v33, v7, v11 row_newbcast:4 row_mask:0xf bank_mask:0xf
  v_and_b32_dpp v34, v7, v12 row_newbcast:4 row_mask:0xf bank_mask:0xf
  v_and_b32_dpp v35, v7, v13 row_newbcast:4 row_mask:0xf bank_mask:0xf
  s_nop 1
  v_mfma_f32_16x16x32_bf16 v[20:23], v[108:111], v[32:35], v[20:23]
  v_mfma_f32_16x16x32_bf16 v[24:27], v[112:115], v[32:35], v[24:27]
  buffer_load_dwordx4 v[100:103], v3, s[12:15], s21 offen offset:0 nt
  buffer_load_dwordx4 v[104:107], v3, s[12:15], s21 offen offset:256 nt
  buffer_load_dwordx4 v[108:111], v3, s[12:15], s21 offen offset:2048 nt
  buffer_load_dwordx4 v[112:115], v3, s[12:15], s21 offen offset:2304 nt
  s_add_u32 s21, s21, 65536
  s_cmp_eq_u32 s55, -1
  s_cbranch_scc1 L_np_15
  s_waitcnt lgkmcnt(0)
  s_add_u32 s54, s54, 4
  v_mov_b32 v233, s55
  v_mov_b32 v234, s54
  s_mov_b64 exec, 1
  ds_write_b32 v233, v234 offset:41024
  s_mov_b64 exec, -1
  s_mov_b32 s55, -1
L_np_15:
  s_mov_b64 exec, 1
  ds_add_rtn_u32 v233, v231, v232 offset:40960
  s_waitcnt lgkmcnt(0)
  v_and_b32 v234, -4, v233
  v_readfirstlane_b32 s5, v233
L_sp_16:
  ds_read_b32 v233, v234 offset:41024
  s_waitcnt lgkmcnt(0)
  v_readfirstlane_b32 s27, v233
  s_cmp_lg_u32 s27, -1
  s_cbranch_scc1 L_sq_17
  s_sub_u32 s43, s43, 1
  s_cbranch_scc1 L_sq_17
  s_branch L_sp_16
L_sq_17:
  s_mov_b64 exec, -1
  s_min_u32 s27, s27, 128
  s_and_b32 s38, s5, 3
  s_lshl2_add_u32 s27, s27, s38
  s_cmp_lg_u32 s38, 3
  s_cbranch_scc1 L_nr_18
  s_cmp_ge_u32 s27, 128
  s_cbranch_scc1 L_nr_18
  s_lshr_b32 s55, s5, 2
  s_lshl2_add_u32 s55, s55, 4
  s_mov_b32 s54, 1
  s_atomic_add s54, s[40:41], 0 glc
L_nr_18:
  s_waitcnt vmcnt(8)
  v_mfma_f32_16x16x32_bf16 v[16:19], v[132:135], v[36:39], 0
  v_mfma_f32_16x16x32_bf16 v[16:19], v[136:139], v[40:43], v[16:19]
  v_mfma_f32_16x16x32_bf16 v[16:19], v[140:143], v[44:47], v[16:19]
  v_mfma_f32_16x16x32_bf16 v[16:19], v[144:147], v[48:51], v[16:19]
  s_add_u32 s20, s27, 384
  s_cmp_ge_u32 s20, 512
  s_cbranch_scc1 L_dD
  s_lshl_b32 s20, s20, 12
  s_add_u32 s20, s20, s3
  s_mov_b32 s21, s20
  buffer_load_dwordx4 v[132:135], v2, s[8:11], s20 offen offset:0 nt
  buffer_load_dwordx4 v[136:139], v2, s[8:11], s20 offen offset:256 nt
  buffer_load_dwordx4 v[140:143], v2, s[8:11], s20 offen offset:2048 nt
  buffer_load_dwordx4 v[144:147], v2, s[8:11], s20 offen offset:2304 nt
  s_add_u32 s20, s20, 65536
  v_cndmask_b32 v6, v16, v17, s[30:31]
  v_cndmask_b32 v6, v6, v18, s[32:33]
  v_cndmask_b32 v6, v6, v19, s[34:35]
  s_nop 1
  v_add_f32_dpp v6, v6, v6 quad_perm:[1,0,3,2] row_mask:0xf bank_mask:0xf
  s_nop 1
  v_add_f32_dpp v6, v6, v6 quad_perm:[2,3,0,1] row_mask:0xf bank_mask:0xf
  v_cvt_pk_bf16_f32 v6, v6, v6
  v_and_b32 v6, 0xffff0000, v6
  v_cndmask_b32 v6, v6, v200, s[28:29]
  v_mov_b32 v8, v6
  s_nop 1
  v_max_f32_dpp v8, v8, v8 row_ror:4 row_mask:0xf bank_mask:0xf
  s_nop 1
  v_max_f32_dpp v8, v8, v8 row_ror:8 row_mask:0xf bank_mask:0xf
  s_nop 1
  v_max_f32_dpp v8, v8, v8 row_bcast:15 row_mask:0xa bank_mask:0xf
  s_nop 1
  v_max_f32_dpp v8, v8, v8 row_bcast:31 row_mask:0xc bank_mask:0xf
  s_nop 0
  v_readlane_b32 s38, v8, 63
  s_nop 1
  v_max_f32 v8, s38, v5
  v_sub_f32 v9, v5, v8
  v_sub_f32 v7, v6, v8
  v_mul_f32 v9, s36, v9
  v_mul_f32 v7, s36, v7
  v_exp_f32 v9, v9
  v_exp_f32 v7, v7
  v_mov_b32 v5, v8
  v_fma_f32 v4, v4, v9, v7
  v_cvt_pk_bf16_f32 v7, v7, v7
  v_mul_f32 v20, v20, v9
  v_mul_f32 v21, v21, v9
  v_mul_f32 v22, v22, v9
  v_mul_f32 v23, v23, v9
  v_mul_f32 v24, v24, v9
  v_mul_f32 v25, v25, v9
  v_mul_f32 v26, v26, v9
  v_mul_f32 v27, v27, v9
  s_waitcnt vmcnt(8)
  v_and_b32_dpp v28, v7, v10 row_newbcast:0 row_mask:0xf bank_mask:0xf
  v_and_b32_dpp v29, v7, v11 row_newbcast:0 row_mask:0xf bank_mask:0xf
  v_and_b32_dpp v30, v7, v12 row_newbcast:0 row_mask:0xf bank_mask:0xf
  v_and_b32_dpp v31, v7, v13 row_newbcast:0 row_mask:0xf bank_mask:0xf
  s_nop 1
  v_mfma_f32_16x16x32_bf16 v[20:23], v[164:167], v[28:31], v[20:23]
  v_mfma_f32_16x16x32_bf16 v[24:27], v[168:171], v[28:31], v[24:27]
  v_and_b32_dpp v32, v7, v10 row_newbcast:4 row_mask:0xf bank_mask:0xf
  v_and_b32_dpp v33, v7, v11 row_newbcast:4 row_mask:0xf bank_mask:0xf
  v_and_b32_dpp v34, v7, v12 row_newbcast:4 row_mask:0xf bank_mask:0xf
  v_and_b32_dpp v35, v7, v13 row_newbcast:4 row_mask:0xf bank_mask:0xf
  s_nop 1
  v_mfma_f32_16x16x32_bf16 v[20:23], v[172:175], v[32:35], v[20:23]
  v_mfma_f32_16x16x32_bf16 v[24:27], v[176:179], v[32:35], v[24:27]
  buffer_load_dwordx4 v[164:167], v3, s[12:15], s21 offen offset:0 nt
  buffer_load_dwordx4 v[168:171], v3, s[12:15], s21 offen offset:256 nt
  buffer_load_dwordx4 v[172:175], v3, s[12:15], s21 offen offset:2048 nt
  buffer_load_dwordx4 v[176:179], v3, s[12:15], s21 offen offset:2304 nt
  s_add_u32 s21, s21, 65536
  s_cmp_eq_u32 s55, -1
  s_cbranch_scc1 L_np_19
  s_waitcnt lgkmcnt(0)
  s_add_u32 s54, s54, 4
  v_mov_b32 v233, s55
  v_mov_b32 v234, s54
  s_mov_b64 exec, 1
  ds_write_b32 v233, v234 offset:41024
  s_mov_b64 exec, -1
  s_mov_b32 s55, -1
L_np_19:
  s_branch L_dl
L_dC:
  s_nop 4
  v_cndmask_b32 v6, v16, v17, s[30:31]
  v_cndmask_b32 v6, v6, v18, s[32:33]
  v_cndmask_b32 v6, v6, v19, s[34:35]
  s_nop 1
  v_add_f32_dpp v6, v6, v6 quad_perm:[1,0,3,2] row_mask:0xf bank_mask:0xf
  s_nop 1
  v_add_f32_dpp v6, v6, v6 quad_perm:[2,3,0,1] row_mask:0xf bank_mask:0xf
  v_cvt_pk_bf16_f32 v6, v6, v6
  v_and_b32 v6, 0xffff0000, v6
  v_cndmask_b32 v6, v6, v200, s[28:29]
  v_mov_b32 v8, v6
  s_nop 1
  v_max_f32_dpp v8, v8, v8 row_ror:4 row_mask:0xf bank_mask:0xf
  s_nop 1
  v_max_f32_dpp v8, v8, v8 row_ror:8 row_mask:0xf bank_mask:0xf
  s_nop 1
  v_max_f32_dpp v8, v8, v8 row_bcast:15 row_mask:0xa bank_mask:0xf
  s_nop 1
  v_max_f32_dpp v8, v8, v8 row_bcast:31 row_mask:0xc bank_mask:0xf
  s_nop 0
  v_readlane_b32 s38, v8, 63
  s_nop 1
  v_max_f32 v8, s38, v5
  v_sub_f32 v9, v5, v8
  v_sub_f32 v7, v6, v8
  v_mul_f32 v9, s36, v9
  v_mul_f32 v7, s36, v7
  v_exp_f32 v9, v9
  v_exp_f32 v7, v7
  v_mov_b32 v5, v8
  v_fma_f32 v4, v4, v9, v7
  v_cvt_pk_bf16_f32 v7, v7, v7
  v_mul_f32 v20, v20, v9
  v_mul_f32 v21, v21, v9
  v_mul_f32 v22, v22, v9
  v_mul_f32 v23, v23, v9
  v_mul_f32 v24, v24, v9
  v_mul_f32 v25, v25, v9
  v_mul_f32 v26, v26, v9
  v_mul_f32 v27, v27, v9
  s_waitcnt vmcnt(8)
  v_and_b32_dpp v28, v7, v10 row_newbcast:0 row_mask:0xf bank_mask:0xf
  v_and_b32_dpp v29, v7, v11 row_newbcast:0 row_mask:0xf bank_mask:0xf
  v_and_b32_dpp v30, v7, v12 row_newbcast:0 row_mask:0xf bank_mask:0xf
  v_and_b32_dpp v31, v7, v13 row_newbcast:0 row_mask:0xf bank_mask:0xf
  s_nop 1
  v_mfma_f32_16x16x32_bf16 v[20:23], v[100:103], v[28:31], v[20:23]
  v_mfma_f32_16x16x32_bf16 v[24:27], v[104:107], v[28:31], v[24:27]
  v_and_b32_dpp v32, v7, v10 row_newbcast:4 row_mask:0xf bank_mask:0xf
  v_and_b32_dpp v33, v7, v11 row_newbcast:4 row_mask:0xf bank_mask:0xf
  v_and_b32_dpp v34, v7, v12 row_newbcast:4 row_mask:0xf bank_mask:0xf
  v_and_b32_dpp v35, v7, v13 row_newbcast:4 row_mask:0xf bank_mask:0xf
  s_nop 1
  v_mfma_f32_16x16x32_bf16 v[20:23], v[108:111], v[32:35], v[20:23]
  v_mfma_f32_16x16x32_bf16 v[24:27], v[112:115], v[32:35], v[24:27]
  s_waitcnt vmcnt(4)
  v_mfma_f32_16x16x32_bf16 v[16:19], v[132:135], v[36:39], 0
  v_mfma_f32_16x16x32_bf16 v[16:19], v[136:139], v[40:43], v[16:19]
  v_mfma_f32_16x16x32_bf16 v[16:19], v[140:143], v[44:47], v[16:19]
  v_mfma_f32_16x16x32_bf16 v[16:19], v[144:147], v[48:51], v[16:19]
  s_nop 7
  v_cndmask_b32 v6, v16, v17, s[30:31]
  v_cndmask_b32 v6, v6, v18, s[32:33]
  v_cndmask_b32 v6, v6, v19, s[34:35]
  s_nop 1
  v_add_f32_dpp v6, v6, v6 quad_perm:[1,0,3,2] row_mask:0xf bank_mask:0xf
  s_nop 1
  v_add_f32_dpp v6, v6, v6 quad_perm:[2,3,0,1] row_mask:0xf bank_mask:0xf
  v_cvt_pk_bf16_f32 v6, v6, v6
  v_and_b32 v6, 0xffff0000, v6
  v_cndmask_b32 v6, v6, v200, s[28:29]
  v_mov_b32 v8, v6
  s_nop 1
  v_max_f32_dpp v8, v8, v8 row_ror:4 row_mask:0xf bank_mask:0xf
  s_nop 1
  v_max_f32_dpp v8, v8, v8 row_ror:8 row_mask:0xf bank_mask:0xf
  s_nop 1
  v_max_f32_dpp v8, v8, v8 row_bcast:15 row_mask:0xa bank_mask:0xf
  s_nop 1
  v_max_f32_dpp v8, v8, v8 row_bcast:31 row_mask:0xc bank_mask:0xf
  s_nop 0
  v_readlane_b32 s38, v8, 63
  s_nop 1
  v_max_f32 v8, s38, v5
  v_sub_f32 v9, v5, v8
  v_sub_f32 v7, v6, v8
  v_mul_f32 v9, s36, v9
  v_mul_f32 v7, s36, v7
  v_exp_f32 v9, v9
  v_exp_f32 v7, v7
  v_mov_b32 v5, v8
  v_fma_f32 v4, v4, v9, v7
  v_cvt_pk_bf16_f32 v7, v7, v7
  v_mul_f32 v20, v20, v9
  v_mul_f32 v21, v21, v9
  v_mul_f32 v22, v22, v9
  v_mul_f32 v23, v23, v9
  v_mul_f32 v24, v24, v9
  v_mul_f32 v25, v25, v9
  v_mul_f32 v26, v26, v9
  v_mul_f32 v27, v27, v9
  v_add_f32_dpp v4, v4, v4 row_ror:4 row_mask:0xf bank_mask:0xf
  s_nop 1
  v_add_f32_dpp v4, v4, v4 row_ror:8 row_mask:0xf bank_mask:0xf
  s_nop 1
  v_add_f32_dpp v4, v4, v4 row_bcast:15 row_mask:0xa bank_mask:0xf
  s_nop 1
  v_add_f32_dpp v4, v4, v4 row_bcast:31 row_mask:0xc bank_mask:0xf
  s_nop 0
  v_readlane_b32 s39, v4, 63
  s_nop 1
  v_mov_b32 v8, s39
  ds_write_b32 v254, v5 offset:4096
  ds_write_b32 v254, v8 offset:4100
  s_waitcnt vmcnt(0)
  v_and_b32_dpp v28, v7, v10 row_newbcast:0 row_mask:0xf bank_mask:0xf
  v_and_b32_dpp v29, v7, v11 row_newbcast:0 row_mask:0xf bank_mask:0xf
  v_and_b32_dpp v30, v7, v12 row_newbcast:0 row_mask:0xf bank_mask:0xf
  v_and_b32_dpp v31, v7, v13 row_newbcast:0 row_mask:0xf bank_mask:0xf
  s_nop 1
  v_mfma_f32_16x16x32_bf16 v[20:23], v[164:167], v[28:31], v[20:23]
  v_mfma_f32_16x16x32_bf16 v[24:27], v[168:171], v[28:31], v[24:27]
  v_and_b32_dpp v32, v7, v10 row_newbcast:4 row_mask:0xf bank_mask:0xf
  v_and_b32_dpp v33, v7, v11 row_newbcast:4 row_mask:0xf bank_mask:0xf
  v_and_b32_dpp v34, v7, v12 row_newbcast:4 row_mask:0xf bank_mask:0xf
  v_and_b32_dpp v35, v7, v13 row_newbcast:4 row_mask:0xf bank_mask:0xf
  s_nop 1
  v_mfma_f32_16x16x32_bf16 v[20:23], v[172:175], v[32:35], v[20:23]
  v_mfma_f32_16x16x32_bf16 v[24:27], v[176:179], v[32:35], v[24:27]
  s_branch L_le
L_wq:
  s_lshl_b32 s25, s24, 10
  s_add_u32 m0, s23, s25
  s_mul_i32 s25, s24, 28672
  s_add_u32 s25, s25, s22
  buffer_load_dwordx4 v244, s[76:79], s25 offen lds
  s_add_u32 s24, s24, 1
  s_cmp_eq_u32 s24, 8
  s_cselect_b32 s24, 4, s24
  s_lshl_b32 s25, s24, 10
  s_add_u32 m0, s23, s25
  s_mul_i32 s25, s24, 28672
  s_add_u32 s25, s25, s22
  buffer_load_dwordx4 v244, s[76:79], s25 offen lds
  s_add_u32 s24, s24, 1
  s_cmp_eq_u32 s24, 8
  s_cselect_b32 s24, 4, s24
  s_lshl_b32 s25, s24, 10
  s_add_u32 m0, s23, s25
  s_mul_i32 s25, s24, 28672
  s_add_u32 s25, s25, s22
  buffer_load_dwordx4 v244, s[76:79], s25 offen lds
  s_add_u32 s24, s24, 1
  s_cmp_eq_u32 s24, 8
  s_cselect_b32 s24, 4, s24
  s_lshl_b32 s25, s24, 10
  s_add_u32 m0, s23, s25
  s_mul_i32 s25, s24, 28672
  s_add_u32 s25, s25, s22
  buffer_load_dwordx4 v244, s[76:79], s25 offen lds
  s_cmp_eq_u32 s5, 0
  s_cbranch_scc1 L_wr0
  s_branch L_wqret
.p2align 12
L_tchC:
  s_branch L_tchCr
L_dD:
  s_nop 4
  v_cndmask_b32 v6, v16, v17, s[30:31]
  v_cndmask_b32 v6, v6, v18, s[32:33]
  v_cndmask_b32 v6, v6, v19, s[34:35]
  s_nop 1
  v_add_f32_dpp v6, v6, v6 quad_perm:[1,0,3,2] row_mask:0xf bank_mask:0xf
  s_nop 1
  v_add_f32_dpp v6, v6, v6 quad_perm:[2,3,0,1] row_mask:0xf bank_mask:0xf
  v_cvt_pk_bf16_f32 v6, v6, v6
  v_and_b32 v6, 0xffff0000, v6
  v_cndmask_b32 v6, v6, v200, s[28:29]
  v_mov_b32 v8, v6
  s_nop 1
  v_max_f32_dpp v8, v8, v8 row_ror:4 row_mask:0xf bank_mask:0xf
  s_nop 1
  v_max_f32_dpp v8, v8, v8 row_ror:8 row_mask:0xf bank_mask:0xf
  s_nop 1
  v_max_f32_dpp v8, v8, v8 row_bcast:15 row_mask:0xa bank_mask:0xf
  s_nop 1
  v_max_f32_dpp v8, v8, v8 row_bcast:31 row_mask:0xc bank_mask:0xf
  s_nop 0
  v_readlane_b32 s38, v8, 63
  s_nop 1
  v_max_f32 v8, s38, v5
  v_sub_f32 v9, v5, v8
  v_sub_f32 v7, v6, v8
  v_mul_f32 v9, s36, v9
  v_mul_f32 v7, s36, v7
  v_exp_f32 v9, v9
  v_exp_f32 v7, v7
  v_mov_b32 v5, v8
  v_fma_f32 v4, v4, v9, v7
  v_cvt_pk_bf16_f32 v7, v7, v7
  v_mul_f32 v20, v20, v9
  v_mul_f32 v21, v21, v9
  v_mul_f32 v22, v22, v9
  v_mul_f32 v23, v23, v9
  v_mul_f32 v24, v24, v9
  v_mul_f32 v25, v25, v9
  v_mul_f32 v26, v26, v9
  v_mul_f32 v27, v27, v9
  s_waitcnt vmcnt(8)
  v_and_b32_dpp v28, v7, v10 row_newbcast:0 row_mask:0xf bank_mask:0xf
  v_and_b32_dpp v29, v7, v11 row_newbcast:0 row_mask:0xf bank_mask:0xf
  v_and_b32_dpp v30, v7, v12 row_newbcast:0 row_mask:0xf bank_mask:0xf
  v_and_b32_dpp v31, v7, v13 row_newbcast:0 row_mask:0xf bank_mask:0xf
  s_nop 1
  v_mfma_f32_16x16x32_bf16 v[20:23], v[164:167], v[28:31], v[20:23]
  v_mfma_f32_16x16x32_bf16 v[24:27], v[168:171], v[28:31], v[24:27]
  v_and_b32_dpp v32, v7, v10 row_newbcast:4 row_mask:0xf bank_mask:0xf
  v_and_b32_dpp v33, v7, v11 row_newbcast:4 row_mask:0xf bank_mask:0xf
  v_and_b32_dpp v34, v7, v12 row_newbcast:4 row_mask:0xf bank_mask:0xf
  v_and_b32_dpp v35, v7, v13 row_newbcast:4 row_mask:0xf bank_mask:0xf
  s_nop 1
  v_mfma_f32_16x16x32_bf16 v[20:23], v[172:175], v[32:35], v[20:23]
  v_mfma_f32_16x16x32_bf16 v[24:27], v[176:179], v[32:35], v[24:27]
L_dE:
  s_waitcnt vmcnt(4)
  v_mfma_f32_16x16x32_bf16 v[16:19], v[68:71], v[36:39], 0
  v_mfma_f32_16x16x32_bf16 v[16:19], v[72:75], v[40:43], v[16:19]
  v_mfma_f32_16x16x32_bf16 v[16:19], v[76:79], v[44:47], v[16:19]
  v_mfma_f32_16x16x32_bf16 v[16:19], v[80:83], v[48:51], v[16:19]
  s_nop 7
  v_cndmask_b32 v6, v16, v17, s[30:31]
  v_cndmask_b32 v6, v6, v18, s[32:33]
  v_cndmask_b32 v6, v6, v19, s[34:35]
  s_nop 1
  v_add_f32_dpp v6, v6, v6 quad_perm:[1,0,3,2] row_mask:0xf bank_mask:0xf
  s_nop 1
  v_add_f32_dpp v6, v6, v6 quad_perm:[2,3,0,1] row_mask:0xf bank_mask:0xf
  v_cvt_pk_bf16_f32 v6, v6, v6
  v_and_b32 v6, 0xffff0000, v6
  v_cndmask_b32 v6, v6, v200, s[28:29]
  v_mov_b32 v8, v6
  s_nop 1
  v_max_f32_dpp v8, v8, v8 row_ror:4 row_mask:0xf bank_mask:0xf
  s_nop 1
  v_max_f32_dpp v8, v8, v8 row_ror:8 row_mask:0xf bank_mask:0xf
  s_nop 1
  v_max_f32_dpp v8, v8, v8 row_bcast:15 row_mask:0xa bank_mask:0xf
  s_nop 1
  v_max_f32_dpp v8, v8, v8 row_bcast:31 row_mask:0xc bank_mask:0xf
  s_nop 0
  v_readlane_b32 s38, v8, 63
  s_nop 1
  v_max_f32 v8, s38, v5
  v_sub_f32 v9, v5, v8
  v_sub_f32 v7, v6, v8
  v_mul_f32 v9, s36, v9
  v_mul_f32 v7, s36, v7
  v_exp_f32 v9, v9
  v_exp_f32 v7, v7
  v_mov_b32 v5, v8
  v_fma_f32 v4, v4, v9, v7
  v_cvt_pk_bf16_f32 v7, v7, v7
  v_mul_f32 v20, v20, v9
  v_mul_f32 v21, v21, v9
  v_mul_f32 v22, v22, v9
  v_mul_f32 v23, v23, v9
  v_mul_f32 v24, v24, v9
  v_mul_f32 v25, v25, v9
  v_mul_f32 v26, v26, v9
  v_mul_f32 v27, v27, v9
  v_add_f32_dpp v4, v4, v4 row_ror:4 row_mask:0xf bank_mask:0xf
  s_nop 1
  v_add_f32_dpp v4, v4, v4 row_ror:8 row_mask:0xf bank_mask:0xf
  s_nop 1
  v_add_f32_dpp v4, v4, v4 row_bcast:15 row_mask:0xa bank_mask:0xf
  s_nop 1
  v_add_f32_dpp v4, v4, v4 row_bcast:31 row_mask:0xc bank_mask:0xf
  s_nop 0
  v_readlane_b32 s39, v4, 63
  s_nop 1
  v_mov_b32 v8, s39
  ds_write_b32 v254, v5 offset:4096
  ds_write_b32 v254, v8 offset:4100
  s_waitcnt vmcnt(0)
  v_and_b32_dpp v28, v7, v10 row_newbcast:0 row_mask:0xf bank_mask:0xf
  v_and_b32_dpp v29, v7, v11 row_newbcast:0 row_mask:0xf bank_mask:0xf
  v_and_b32_dpp v30, v7, v12 row_newbcast:0 row_mask:0xf bank_mask:0xf
  v_and_b32_dpp v31, v7, v13 row_newbcast:0 row_mask:0xf bank_mask:0xf
  s_nop 1
  v_mfma_f32_16x16x32_bf16 v[20:23], v[100:103], v[28:31], v[20:23]
  v_mfma_f32_16x16x32_bf16 v[24:27], v[104:107], v[28:31], v[24:27]
  v_and_b32_dpp v32, v7, v10 row_newbcast:4 row_mask:0xf bank_mask:0xf
  v_and_b32_dpp v33, v7, v11 row_newbcast:4 row_mask:0xf bank_mask:0xf
  v_and_b32_dpp v34, v7, v12 row_newbcast:4 row_mask:0xf bank_mask:0xf
  v_and_b32_dpp v35, v7, v13 row_newbcast:4 row_mask:0xf bank_mask:0xf
  s_nop 1
  v_mfma_f32_16x16x32_bf16 v[20:23], v[108:111], v[32:35], v[20:23]
  v_mfma_f32_16x16x32_bf16 v[24:27], v[112:115], v[32:35], v[24:27]
L_le:
  s_mov_b32 exec_lo, 0x00ff00ff
  s_mov_b32 exec_hi, 0x00ff00ff
  s_nop 4
  ds_write_b32 v253, v20 offset:0
  ds_write_b32 v253, v21 offset:32
  ds_write_b32 v253, v22 offset:64
  ds_write_b32 v253, v23 offset:96
  ds_write_b32 v253, v24 offset:512
  ds_write_b32 v253, v25 offset:544
  ds_write_b32 v253, v26 offset:576
  ds_write_b32 v253, v27 offset:608
  s_mov_b64 exec, -1
  v_lshlrev_b32 v2, 4, v1
  v_mov_b32 v8, 0
  v_mov_b32 v3, v255
  v_lshlrev_b32 v9, 3, v1
  s_waitcnt lgkmcnt(0)
  s_barrier
  s_cmp_lg_u32 s4, 0
  s_cbranch_scc1 L_role
L_pubA:
  ds_read_b128 v[36:39], v8 offset:4096
  ds_read_b128 v[40:43], v8 offset:4112
  ds_read_b128 v[44:47], v3 offset:0
  ds_read_b128 v[48:51], v3 offset:1024
  ds_read_b128 v[52:55], v3 offset:2048
  ds_read_b128 v[56:59], v3 offset:3072
  s_waitcnt lgkmcnt(4)
  v_max_f32 v5, v36, v38
  v_max3_f32 v5, v5, v40, v42
  v_sub_f32 v36, v36, v5
  v_sub_f32 v38, v38, v5
  v_sub_f32 v40, v40, v5
  v_sub_f32 v42, v42, v5
  v_mul_f32 v36, s36, v36
  v_mul_f32 v38, s36, v38
  v_mul_f32 v40, s36, v40
  v_mul_f32 v42, s36, v42
  v_exp_f32 v36, v36
  v_exp_f32 v38, v38
  v_exp_f32 v40, v40
  v_exp_f32 v42, v42
  v_min_u32 v16, -2, v5
  v_mul_f32 v17, v36, v37
  v_fmac_f32 v17, v38, v39
  v_fmac_f32 v17, v40, v41
  v_fmac_f32 v17, v42, v43
  s_waitcnt lgkmcnt(0)
  v_mul_f32 v24, v36, v44
  v_mul_f32 v25, v36, v45
  v_mul_f32 v26, v36, v46
  v_mul_f32 v27, v36, v47
  v_fmac_f32 v24, v38, v48
  v_fmac_f32 v25, v38, v49
  v_fmac_f32 v26, v38, v50
  v_fmac_f32 v27, v38, v51
  v_fmac_f32 v24, v40, v52
  v_fmac_f32 v25, v40, v53
  v_fmac_f32 v26, v40, v54
  v_fmac_f32 v27, v40, v55
  v_fmac_f32 v24, v42, v56
  v_fmac_f32 v25, v42, v57
  v_fmac_f32 v26, v42, v58
  v_fmac_f32 v27, v42, v59
  v_cvt_pk_bf16_f32 v20, v24, v25
  v_cvt_pk_bf16_f32 v21, v26, v27
  v_mov_b32 v18, v16
  v_min_u32 v20, -2, v20
  v_mov_b32 v19, v17
  buffer_store_dwordx2 v[20:21], v9, s[16:19], s6 offen sc1
  s_mov_b64 exec, 0xff
  buffer_store_dwordx4 v[16:19], v2, s[16:19], s7 offen sc1
  s_mov_b64 exec, -1
  s_cmp_eq_u32 s74, 0
  s_cbranch_scc1 L_role
  s_waitcnt vmcnt(0)
L_role:
  s_barrier
  s_cmp_lg_u32 s74, 0
  s_cbranch_scc1 L_notW
  s_mov_b32 s5, 0
  s_cmp_eq_u32 s74, 0
  s_cbranch_scc1 L_wq
L_wr0:
  buffer_load_dwordx4 v[136:139], v2, s[16:19], s59 offen offset:1024 sc1
  buffer_load_dwordx4 v[132:135], v2, s[16:19], s59 offen offset:0 sc1
  buffer_load_dwordx4 v[128:131], v2, s[16:19], s56 offen offset:3072 sc1
  buffer_load_dwordx4 v[124:127], v2, s[16:19], s56 offen offset:2048 sc1
  buffer_load_dwordx4 v[120:123], v2, s[16:19], s56 offen offset:1024 sc1
  buffer_load_dwordx4 v[116:119], v2, s[16:19], s56 offen offset:0 sc1
  buffer_load_dwordx4 v[112:115], v2, s[16:19], s26 offen offset:3072 sc1
  buffer_load_dwordx4 v[108:111], v2, s[16:19], s26 offen offset:2048 sc1
  buffer_load_dwordx4 v[104:107], v2, s[16:19], s26 offen offset:1024 sc1
  buffer_load_dwordx4 v[100:103], v2, s[16:19], s26 offen offset:0 sc1
  v_and_b32 v3, 15, v1
  v_lshrrev_b32 v6, 2, v1
  v_lshlrev_b32 v6, 5, v6
  v_and_b32 v8, 3, v1
  v_lshl_add_u32 v6, v8, 3, v6
  s_lshl_b32 s5, s4, 13
  v_add_u32 v6, s5, v6
  s_mul_i32 s5, s4, 10560
  s_add_u32 s5, s5, 38144
  v_lshrrev_b32 v7, 5, v1
  v_lshl_add_u32 v7, v7, 4, v2
  v_add_u32 v7, s5, v7
  v_mul_u32_u24 v4, 528, v3
  v_lshrrev_b32 v8, 4, v1
  v_lshl_add_u32 v4, v8, 4, v4
  v_add_u32 v4, s5, v4
  v_lshrrev_b32 v28, 2, v3
  v_mul_u32_u24 v28, 16, v28
  v_lshl_add_u32 v28, v3, 7, v28
  v_and_b32 v15, 7, v1
  v_lshl_add_u32 v28, v15, 4, v28
  v_add_u32 v28, s5, v28
  v_lshlrev_b32 v3, 6, v3
  v_lshl_add_u32 v3, v8, 4, v3
  s_lshl_b32 s5, s4, 8
  v_add_u32 v29, s5, v3
  v_bfe_u32 v15, v1, 1, 1
  v_lshlrev_b32 v15, 6, v15
  v_bfe_u32 v8, v1, 2, 2
  v_lshl_add_u32 v15, v8, 4, v15
  v_and_b32 v8, 1, v1
  v_lshl_add_u32 v15, v8, 3, v15
  v_lshrrev_b32 v8, 4, v1
  v_mul_u32_u24 v8, 14592, v8
  v_add_u32 v15, v15, v8
  v_and_b32 v30, 0xf0, v2
  s_mul_i32 s54, s75, 7168
  s_lshl_b32 s6, s73, 8
  s_add_u32 s54, s54, s6
  s_lshr_b32 s55, s54, 1
  s_add_u32 s54, s54, 532480
  s_add_u32 s55, s55, 2097152
  s_mul_i32 s55, s75, 3584
  s_lshr_b32 s6, s73, 1
  s_mul_i32 s6, s6, 0
  s_add_u32 s55, s55, s6
  s_lshl_b32 s6, s73, 7
  s_add_u32 s55, s55, s6
  s_add_u32 s55, s55, 2097152
  s_mul_i32 s6, s4, 58368
  s_add_u32 s55, s55, s6
  s_cmp_lt_u32 s4, 2
  s_cselect_b32 s55, s55, 4194304
  s_cmp_eq_u32 s4, 2
  s_cselect_b32 s54, s54, 4194304
  v_lshlrev_b32 v214, 16, v212
  v_and_b32 v215, 0xffff0000, v212
  v_lshlrev_b32 v216, 16, v213
  v_and_b32 v217, 0xffff0000, v213
  s_waitcnt vmcnt(10)
  ds_read_b64_tr_b16 v[68:69], v6 offset:5376
  ds_read_b64_tr_b16 v[70:71], v6 offset:5888
  ds_read_b64_tr_b16 v[72:73], v6 offset:6400
  ds_read_b64_tr_b16 v[74:75], v6 offset:6912
  ds_read_b64_tr_b16 v[76:77], v6 offset:7424
  ds_read_b64_tr_b16 v[78:79], v6 offset:7936
  ds_read_b64_tr_b16 v[80:81], v6 offset:8448
  ds_read_b64_tr_b16 v[82:83], v6 offset:8960
  ds_read_b64_tr_b16 v[84:85], v6 offset:9472
  ds_read_b64_tr_b16 v[86:87], v6 offset:9984
  ds_read_b64_tr_b16 v[88:89], v6 offset:10496
  ds_read_b64_tr_b16 v[90:91], v6 offset:11008
  ds_read_b64_tr_b16 v[92:93], v6 offset:11520
  ds_read_b64_tr_b16 v[94:95], v6 offset:12032
  ds_read_b64_tr_b16 v[96:97], v6 offset:12544
  ds_read_b64_tr_b16 v[98:99], v6 offset:13056
  s_mov_b32 s24, 0
  s_waitcnt vmcnt(9)
  v_max_u32 v8, v136, v138
  v_cmp_eq_u32 vcc, -1, v8
  ds_write_b128 v7, v[136:139] offset:9504
  s_cmp_lg_u64 vcc, 0
  s_addc_u32 s24, s24, s24
  s_waitcnt vmcnt(8)
  v_max_u32 v8, v132, v134
  v_cmp_eq_u32 vcc, -1, v8
  ds_write_b128 v7, v[132:135] offset:8448
  s_cmp_lg_u64 vcc, 0
  s_addc_u32 s24, s24, s24
  s_waitcnt vmcnt(7)
  v_max_u32 v8, v128, v130
  v_cmp_eq_u32 vcc, -1, v8
  ds_write_b128 v7, v[128:131] offset:7392
  s_cmp_lg_u64 vcc, 0
  s_addc_u32 s24, s24, s24
  s_waitcnt vmcnt(6)
  v_max_u32 v8, v124, v126
  v_cmp_eq_u32 vcc, -1, v8
  ds_write_b128 v7, v[124:127] offset:6336
  s_cmp_lg_u64 vcc, 0
  s_addc_u32 s24, s24, s24
  s_waitcnt vmcnt(5)
  v_max_u32 v8, v120, v122
  v_cmp_eq_u32 vcc, -1, v8
  ds_write_b128 v7, v[120:123] offset:5280
  s_cmp_lg_u64 vcc, 0
  s_addc_u32 s24, s24, s24
  s_waitcnt vmcnt(4)
  v_max_u32 v8, v116, v118
  v_cmp_eq_u32 vcc, -1, v8
  ds_write_b128 v7, v[116:119] offset:4224
  s_cmp_lg_u64 vcc, 0
  s_addc_u32 s24, s24, s24
  s_waitcnt vmcnt(3)
  v_max_u32 v8, v112, v114
  v_cmp_eq_u32 vcc, -1, v8
  ds_write_b128 v7, v[112:115] offset:3168
  s_cmp_lg_u64 vcc, 0
  s_addc_u32 s24, s24, s24
  s_waitcnt vmcnt(2)
  v_max_u32 v8, v108, v110
  v_cmp_eq_u32 vcc, -1, v8
  ds_write_b128 v7, v[108:111] offset:2112
  s_cmp_lg_u64 vcc, 0
  s_addc_u32 s24, s24, s24
  s_waitcnt vmcnt(1)
  v_max_u32 v8, v104, v106
  v_cmp_eq_u32 vcc, -1, v8
  ds_write_b128 v7, v[104:107] offset:1056
  s_cmp_lg_u64 vcc, 0
  s_addc_u32 s24, s24, s24
  s_waitcnt vmcnt(0)
  v_max_u32 v8, v100, v102
  v_cmp_eq_u32 vcc, -1, v8
  ds_write_b128 v7, v[100:103] offset:0
  s_cmp_lg_u64 vcc, 0
  s_addc_u32 s24, s24, s24
  s_cmp_eq_u32 s24, 0
  s_cbranch_scc1 L_wdone
L_wl:
  s_sub_u32 s43, s43, 1
  s_cbranch_scc1 L_wdone
  s_mov_b32 s6, s24
  s_ff1_i32_b32 s30, s6
  s_bitset0_b32 s6, s30
  s_lshl_b32 s38, s30, 10
  s_add_u32 s38, s38, s26
  buffer_load_dwordx4 v[100:103], v2, s[16:19], s38 offen sc1
  s_ff1_i32_b32 s30, s6
  s_cmp_lt_i32 s30, 0
  s_cbranch_scc1 L_wchk
  s_bitset0_b32 s6, s30
  s_lshl_b32 s38, s30, 10
  s_add_u32 s38, s38, s26
  buffer_load_dwordx4 v[104:107], v2, s[16:19], s38 offen sc1
  s_ff1_i32_b32 s30, s6
  s_cmp_lt_i32 s30, 0
  s_cbranch_scc1 L_wchk
  s_bitset0_b32 s6, s30
  s_lshl_b32 s38, s30, 10
  s_add_u32 s38, s38, s26
  buffer_load_dwordx4 v[108:111], v2, s[16:19], s38 offen sc1
  s_ff1_i32_b32 s30, s6
  s_cmp_lt_i32 s30, 0
  s_cbranch_scc1 L_wchk
  s_bitset0_b32 s6, s30
  s_lshl_b32 s38, s30, 10
  s_add_u32 s38, s38, s26
  buffer_load_dwordx4 v[112:115], v2, s[16:19], s38 offen sc1
  s_ff1_i32_b32 s30, s6
  s_cmp_lt_i32 s30, 0
  s_cbranch_scc1 L_wchk
  s_bitset0_b32 s6, s30
  s_lshl_b32 s38, s30, 10
  s_add_u32 s38, s38, s26
  buffer_load_dwordx4 v[116:119], v2, s[16:19], s38 offen sc1
  s_ff1_i32_b32 s30, s6
  s_cmp_lt_i32 s30, 0
  s_cbranch_scc1 L_wchk
  s_bitset0_b32 s6, s30
  s_lshl_b32 s38, s30, 10
  s_add_u32 s38, s38, s26
  buffer_load_dwordx4 v[120:123], v2, s[16:19], s38 offen sc1
  s_ff1_i32_b32 s30, s6
  s_cmp_lt_i32 s30, 0
  s_cbranch_scc1 L_wchk
  s_bitset0_b32 s6, s30
  s_lshl_b32 s38, s30, 10
  s_add_u32 s38, s38, s26
  buffer_load_dwordx4 v[124:127], v2, s[16:19], s38 offen sc1
  s_ff1_i32_b32 s30, s6
  s_cmp_lt_i32 s30, 0
  s_cbranch_scc1 L_wchk
  s_bitset0_b32 s6, s30
  s_lshl_b32 s38, s30, 10
  s_add_u32 s38, s38, s26
  buffer_load_dwordx4 v[128:131], v2, s[16:19], s38 offen sc1
  s_ff1_i32_b32 s30, s6
  s_cmp_lt_i32 s30, 0
  s_cbranch_scc1 L_wchk
  s_bitset0_b32 s6, s30
  s_lshl_b32 s38, s30, 10
  s_add_u32 s38, s38, s26
  buffer_load_dwordx4 v[132:135], v2, s[16:19], s38 offen sc1
  s_ff1_i32_b32 s30, s6
  s_cmp_lt_i32 s30, 0
  s_cbranch_scc1 L_wchk
  s_bitset0_b32 s6, s30
  s_lshl_b32 s38, s30, 10
  s_add_u32 s38, s38, s26
  buffer_load_dwordx4 v[136:139], v2, s[16:19], s38 offen sc1
L_wchk:
  s_mov_b32 s6, s24
  s_ff1_i32_b32 s30, s6
  s_bitset0_b32 s6, s30
  s_mul_i32 s38, s30, 1056
  v_add_u32 v6, s38, v7
  s_lshl_b32 s31, 1, s30
  s_waitcnt vmcnt(0)
  v_max_u32 v8, v100, v102
  v_cmp_eq_u32 vcc, -1, v8
  ds_write_b128 v6, v[100:103]
  s_cmp_lg_u64 vcc, 0
  s_cselect_b32 s31, 0, s31
  s_andn2_b32 s24, s24, s31
  s_ff1_i32_b32 s30, s6
  s_cmp_lt_i32 s30, 0
  s_cbranch_scc1 L_wc0
  s_bitset0_b32 s6, s30
  s_mul_i32 s38, s30, 1056
  v_add_u32 v6, s38, v7
  s_lshl_b32 s31, 1, s30
  v_max_u32 v8, v104, v106
  v_cmp_eq_u32 vcc, -1, v8
  ds_write_b128 v6, v[104:107]
  s_cmp_lg_u64 vcc, 0
  s_cselect_b32 s31, 0, s31
  s_andn2_b32 s24, s24, s31
  s_ff1_i32_b32 s30, s6
  s_cmp_lt_i32 s30, 0
  s_cbranch_scc1 L_wc0
  s_bitset0_b32 s6, s30
  s_mul_i32 s38, s30, 1056
  v_add_u32 v6, s38, v7
  s_lshl_b32 s31, 1, s30
  v_max_u32 v8, v108, v110
  v_cmp_eq_u32 vcc, -1, v8
  ds_write_b128 v6, v[108:111]
  s_cmp_lg_u64 vcc, 0
  s_cselect_b32 s31, 0, s31
  s_andn2_b32 s24, s24, s31
  s_ff1_i32_b32 s30, s6
  s_cmp_lt_i32 s30, 0
  s_cbranch_scc1 L_wc0
  s_bitset0_b32 s6, s30
  s_mul_i32 s38, s30, 1056
  v_add_u32 v6, s38, v7
  s_lshl_b32 s31, 1, s30
  v_max_u32 v8, v112, v114
  v_cmp_eq_u32 vcc, -1, v8
  ds_write_b128 v6, v[112:115]
  s_cmp_lg_u64 vcc, 0
  s_cselect_b32 s31, 0, s31
  s_andn2_b32 s24, s24, s31
  s_ff1_i32_b32 s30, s6
  s_cmp_lt_i32 s30, 0
  s_cbranch_scc1 L_wc0
  s_bitset0_b32 s6, s30
  s_mul_i32 s38, s30, 1056
  v_add_u32 v6, s38, v7
  s_lshl_b32 s31, 1, s30
  v_max_u32 v8, v116, v118
  v_cmp_eq_u32 vcc, -1, v8
  ds_write_b128 v6, v[116:119]
  s_cmp_lg_u64 vcc, 0
  s_cselect_b32 s31, 0, s31
  s_andn2_b32 s24, s24, s31
  s_ff1_i32_b32 s30, s6
  s_cmp_lt_i32 s30, 0
  s_cbranch_scc1 L_wc0
  s_bitset0_b32 s6, s30
  s_mul_i32 s38, s30, 1056
  v_add_u32 v6, s38, v7
  s_lshl_b32 s31, 1, s30
  v_max_u32 v8, v120, v122
  v_cmp_eq_u32 vcc, -1, v8
  ds_write_b128 v6, v[120:123]
  s_cmp_lg_u64 vcc, 0
  s_cselect_b32 s31, 0, s31
  s_andn2_b32 s24, s24, s31
  s_ff1_i32_b32 s30, s6
  s_cmp_lt_i32 s30, 0
  s_cbranch_scc1 L_wc0
  s_bitset0_b32 s6, s30
  s_mul_i32 s38, s30, 1056
  v_add_u32 v6, s38, v7
  s_lshl_b32 s31, 1, s30
  v_max_u32 v8, v124, v126
  v_cmp_eq_u32 vcc, -1, v8
  ds_write_b128 v6, v[124:127]
  s_cmp_lg_u64 vcc, 0
  s_cselect_b32 s31, 0, s31
  s_andn2_b32 s24, s24, s31
  s_ff1_i32_b32 s30, s6
  s_cmp_lt_i32 s30, 0
  s_cbranch_scc1 L_wc0
  s_bitset0_b32 s6, s30
  s_mul_i32 s38, s30, 1056
  v_add_u32 v6, s38, v7
  s_lshl_b32 s31, 1, s30
  v_max_u32 v8, v128, v130
  v_cmp_eq_u32 vcc, -1, v8
  ds_write_b128 v6, v[128:131]
  s_cmp_lg_u64 vcc, 0
  s_cselect_b32 s31, 0, s31
  s_andn2_b32 s24, s24, s31
  s_ff1_i32_b32 s30, s6
  s_cmp_lt_i32 s30, 0
  s_cbranch_scc1 L_wc0
  s_bitset0_b32 s6, s30
  s_mul_i32 s38, s30, 1056
  v_add_u32 v6, s38, v7
  s_lshl_b32 s31, 1, s30
  v_max_u32 v8, v132, v134
  v_cmp_eq_u32 vcc, -1, v8
  ds_write_b128 v6, v[132:135]
  s_cmp_lg_u64 vcc, 0
  s_cselect_b32 s31, 0, s31
  s_andn2_b32 s24, s24, s31
  s_ff1_i32_b32 s30, s6
  s_cmp_lt_i32 s30, 0
  s_cbranch_scc1 L_wc0
  s_bitset0_b32 s6, s30
  s_mul_i32 s38, s30, 1056
  v_add_u32 v6, s38, v7
  s_lshl_b32 s31, 1, s30
  v_max_u32 v8, v136, v138
  v_cmp_eq_u32 vcc, -1, v8
  ds_write_b128 v6, v[136:139]
  s_cmp_lg_u64 vcc, 0
  s_cselect_b32 s31, 0, s31
  s_andn2_b32 s24, s24, s31
L_wc0:
  s_cmp_lg_u32 s24, 0
  s_cbranch_scc1 L_wl
L_wdone:
  ds_read_b64 v[164:165], v28 offset:8448
  ds_read_b128 v[168:171], v4 offset:0
  ds_read_b128 v[172:175], v4 offset:64
  ds_read_b128 v[176:179], v4 offset:128
  ds_read_b128 v[180:183], v4 offset:192
  ds_read_b128 v[184:187], v4 offset:256
  ds_read_b128 v[188:191], v4 offset:320
  ds_read_b128 v[192:195], v4 offset:384
  ds_read_b128 v[196:199], v4 offset:448
  s_waitcnt lgkmcnt(6)
  v_max_f32_dpp v5, v164, v164 row_ror:4 row_mask:0xf bank_mask:0xf
  v_mfma_f32_16x16x32_bf16 v[16:19], v[68:71], v[168:171], 0
  s_nop 0
  v_max_f32_dpp v5, v5, v5 row_ror:8 row_mask:0xf bank_mask:0xf
  v_mfma_f32_16x16x32_bf16 v[16:19], v[72:75], v[172:175], v[16:19]
  v_sub_f32 v5, v164, v5
  v_mul_f32 v5, s36, v5
  s_waitcnt lgkmcnt(4)
  v_mfma_f32_16x16x32_bf16 v[16:19], v[76:79], v[176:179], v[16:19]
  v_exp_f32 v5, v5
  v_mfma_f32_16x16x32_bf16 v[16:19], v[80:83], v[180:183], v[16:19]
  v_mul_f32 v8, v5, v165
  s_waitcnt lgkmcnt(2)
  v_mfma_f32_16x16x32_bf16 v[16:19], v[84:87], v[184:187], v[16:19]
  v_add_f32_dpp v8, v8, v8 row_ror:4 row_mask:0xf bank_mask:0xf
  v_mfma_f32_16x16x32_bf16 v[16:19], v[88:91], v[188:191], v[16:19]
  s_nop 0
  v_add_f32_dpp v8, v8, v8 row_ror:8 row_mask:0xf bank_mask:0xf
  s_waitcnt lgkmcnt(0)
  v_mfma_f32_16x16x32_bf16 v[16:19], v[92:95], v[192:195], v[16:19]
  v_rcp_f32 v8, v8
  v_mfma_f32_16x16x32_bf16 v[16:19], v[96:99], v[196:199], v[16:19]
  v_mul_f32 v5, v5, v8
  s_nop 6
  v_mul_f32 v16, v16, v5
  v_mul_f32 v17, v17, v5
  v_mul_f32 v18, v18, v5
  v_mul_f32 v19, v19, v5
  v_add_f32_dpp v16, v16, v16 row_ror:4 row_mask:0xf bank_mask:0xf
  v_add_f32_dpp v17, v17, v17 row_ror:4 row_mask:0xf bank_mask:0xf
  v_add_f32_dpp v18, v18, v18 row_ror:4 row_mask:0xf bank_mask:0xf
  v_add_f32_dpp v19, v19, v19 row_ror:4 row_mask:0xf bank_mask:0xf
  v_add_f32_dpp v16, v16, v16 row_ror:8 row_mask:0xf bank_mask:0xf
  v_add_f32_dpp v17, v17, v17 row_ror:8 row_mask:0xf bank_mask:0xf
  v_add_f32_dpp v18, v18, v18 row_ror:8 row_mask:0xf bank_mask:0xf
  v_add_f32_dpp v19, v19, v19 row_ror:8 row_mask:0xf bank_mask:0xf
  s_and_b32 exec_lo, 0x000f000f, s68
  s_and_b32 exec_hi, 0x000f000f, s68
  ds_write_b128 v29, v[16:19] offset:4160
  s_waitcnt lgkmcnt(0)
  s_barrier
L_wnb:
  s_mov_b64 exec, s[68:69]
  v_mov_b32 v8, v30
  ds_read_b128 v[16:19], v8 offset:4160
  ds_read_b128 v[20:23], v8 offset:4416
  ds_read_b128 v[24:27], v8 offset:4672
  ds_read_b128 v[28:31], v8 offset:4928
  s_waitcnt lgkmcnt(2)
  v_pk_add_f32 v[16:17], v[16:17], v[20:21]
  v_pk_add_f32 v[18:19], v[18:19], v[22:23]
  s_waitcnt lgkmcnt(0)
  v_pk_add_f32 v[24:25], v[24:25], v[28:29]
  v_pk_add_f32 v[26:27], v[26:27], v[30:31]
  v_pk_add_f32 v[16:17], v[16:17], v[24:25]
  v_pk_add_f32 v[18:19], v[18:19], v[26:27]
  v_pk_add_f32 v[20:21], v[16:17], v[214:215]
  v_pk_add_f32 v[22:23], v[18:19], v[216:217]
  v_cvt_pk_bf16_f32 v20, v20, v21
  v_cvt_pk_bf16_f32 v21, v22, v23
  v_min_u32 v20, -2, v20
  buffer_store_dwordx2 v[20:21], v15, s[16:19], s55 offen sc1
  s_mov_b64 exec, 0xffff
  v_bfi_b32 v16, s48, v14, v16
  v_bfi_b32 v17, s48, v14, v17
  v_bfi_b32 v18, s48, v14, v18
  v_bfi_b32 v19, s48, v14, v19
  buffer_store_dwordx4 v[16:19], v2, s[16:19], s54 offen sc1
L_wx:
  s_endpgm
L_D:
  s_and_b32 s5, s2, 7
  s_cmp_eq_u32 s5, 7
  s_cbranch_scc1 L_fin
  s_bfe_u32 s6, s2, 0x20003
  s_lshl2_add_u32 s73, s5, s6
  v_lshrrev_b32 v9, 4, v1
  v_and_b32 v6, 15, v1
  v_mul_u32_u24 v5, 896, v9
  v_lshl_add_u32 v5, v6, 1, v5
  v_lshlrev_b32 v4, 2, v1
  s_lshl_b32 s56, s73, 5
  s_lshl_b32 s55, s73, 8
  s_add_u32 s55, s55, 532480
  buffer_load_ushort v7, v5, s[44:47], s56 offen
  s_or_b32 s5, s73, s4
  s_cselect_b32 s5, 0x400000, 0
  v_mov_b32 v36, 0
  s_mov_b64 exec, 1
  buffer_store_dword v14, v36, s[16:19], s5 offen sc1
  s_mov_b64 exec, -1
  s_add_u32 s60, s55, 7168
  s_add_u32 s61, s55, 14336
  s_add_u32 s62, s55, 21504
  s_mov_b32 s76, s66
  s_mov_b32 s77, s67
  s_mov_b32 s78, 3584
  s_mov_b32 s80, s64
  s_mov_b32 s81, s65
  s_mov_b32 s82, 1605632
  buffer_load_ushort v124, v5, s[76:79], s56 offen
  v_and_b32 v15, 3, v1
  v_bfe_u32 v8, v1, 2, 2
  v_lshlrev_b32 v38, 8, v8
  v_lshl_add_u32 v38, v9, 6, v38
  v_lshl_add_u32 v41, v15, 4, v38
  v_mov_b32 v38, 0x40000000
  v_cmp_gt_u32 vcc, 2, v8
  s_nop 1
  v_cndmask_b32 v38, v38, v41, vcc
  v_lshl_add_u32 v39, v9, 3, v8
  v_lshlrev_b32 v39, 5, v39
  v_lshl_add_u32 v39, v15, 3, v39
  s_mul_i32 s23, s4, 14336
  v_add_u32 v39, s23, v39
  v_lshrrev_b32 v3, 1, v1
  v_mul_u32_u24 v3, 896, v3
  v_and_b32 v15, 1, v1
  v_lshl_add_u32 v3, v15, 4, v3
  v_and_b32 v15, 3, v1
  v_lshlrev_b32 v40, 4, v9
  v_lshl_add_u32 v40, v15, 6, v40
  s_lshl_b32 s5, s4, 8
  v_add_u32 v40, s5, v40
  v_mov_b32 v2, v41
  s_mul_i32 s22, s4, 401408
  s_add_u32 s22, s22, s56
  s_add_u32 s23, s23, 5376
  s_and_b32 s5, s2, 7
  s_mul_i32 s25, s5, 14592
  s_mul_i32 s5, s4, 3584
  s_add_u32 s25, s25, s5
  s_add_u32 s25, s25, 2621440
  s_bfe_u32 s24, s2, 0x20003
  s_mul_i32 s24, s24, 7
  s_lshr_b32 s24, s24, 1
  s_lshl_b32 s5, s24, 10
  s_add_u32 m0, s23, s5
  s_mul_i32 s5, s24, 28672
  s_add_u32 s5, s5, s22
  buffer_load_dwordx4 v3, s[80:83], s5 offen lds
  s_add_u32 s24, s24, 1
  s_cmp_eq_u32 s24, 14
  s_cselect_b32 s24, 0, s24
  s_lshl_b32 s5, s24, 10
  s_add_u32 m0, s23, s5
  s_mul_i32 s5, s24, 28672
  s_add_u32 s5, s5, s22
  buffer_load_dwordx4 v3, s[80:83], s5 offen lds
  s_add_u32 s24, s24, 1
  s_cmp_eq_u32 s24, 14
  s_cselect_b32 s24, 0, s24
  s_lshl_b32 s5, s24, 10
  s_add_u32 m0, s23, s5
  s_mul_i32 s5, s24, 28672
  s_add_u32 s5, s5, s22
  buffer_load_dwordx4 v3, s[80:83], s5 offen lds
  s_add_u32 s24, s24, 1
  s_cmp_eq_u32 s24, 14
  s_cselect_b32 s24, 0, s24
  s_lshl_b32 s5, s24, 10
  s_add_u32 m0, s23, s5
  s_mul_i32 s5, s24, 28672
  s_add_u32 s5, s5, s22
  buffer_load_dwordx4 v3, s[80:83], s5 offen lds
  s_add_u32 s24, s24, 1
  s_cmp_eq_u32 s24, 14
  s_cselect_b32 s24, 0, s24
  s_lshl_b32 s5, s24, 10
  s_add_u32 m0, s23, s5
  s_mul_i32 s5, s24, 28672
  s_add_u32 s5, s5, s22
  buffer_load_dwordx4 v3, s[80:83], s5 offen lds
  s_add_u32 s24, s24, 1
  s_cmp_eq_u32 s24, 14
  s_cselect_b32 s24, 0, s24
  s_lshl_b32 s5, s24, 10
  s_add_u32 m0, s23, s5
  s_mul_i32 s5, s24, 28672
  s_add_u32 s5, s5, s22
  buffer_load_dwordx4 v3, s[80:83], s5 offen lds
  s_add_u32 s24, s24, 1
  s_cmp_eq_u32 s24, 14
  s_cselect_b32 s24, 0, s24
  s_lshl_b32 s5, s24, 10
  s_add_u32 m0, s23, s5
  s_mul_i32 s5, s24, 28672
  s_add_u32 s5, s5, s22
  buffer_load_dwordx4 v3, s[80:83], s5 offen lds
  s_add_u32 s24, s24, 1
  s_cmp_eq_u32 s24, 14
  s_cselect_b32 s24, 0, s24
  s_lshl_b32 s5, s24, 10
  s_add_u32 m0, s23, s5
  s_mul_i32 s5, s24, 28672
  s_add_u32 s5, s5, s22
  buffer_load_dwordx4 v3, s[80:83], s5 offen lds
  s_add_u32 s24, s24, 1
  s_cmp_eq_u32 s24, 14
  s_cselect_b32 s24, 0, s24
  s_lshl_b32 s5, s24, 10
  s_add_u32 m0, s23, s5
  s_mul_i32 s5, s24, 28672
  s_add_u32 s5, s5, s22
  buffer_load_dwordx4 v3, s[80:83], s5 offen lds
  s_add_u32 s24, s24, 1
  s_cmp_eq_u32 s24, 14
  s_cselect_b32 s24, 0, s24
  s_lshl_b32 s5, s24, 10
  s_add_u32 m0, s23, s5
  s_mul_i32 s5, s24, 28672
  s_add_u32 s5, s5, s22
  buffer_load_dwordx4 v3, s[80:83], s5 offen lds
  s_add_u32 s24, s24, 1
  s_cmp_eq_u32 s24, 14
  s_cselect_b32 s24, 0, s24
  s_lshl_b32 s5, s24, 10
  s_add_u32 m0, s23, s5
  s_mul_i32 s5, s24, 28672
  s_add_u32 s5, s5, s22
  buffer_load_dwordx4 v3, s[80:83], s5 offen lds
  s_add_u32 s24, s24, 1
  s_cmp_eq_u32 s24, 14
  s_cselect_b32 s24, 0, s24
  s_lshl_b32 s5, s24, 10
  s_add_u32 m0, s23, s5
  s_mul_i32 s5, s24, 28672
  s_add_u32 s5, s5, s22
  buffer_load_dwordx4 v3, s[80:83], s5 offen lds
  s_add_u32 s24, s24, 1
  s_cmp_eq_u32 s24, 14
  s_cselect_b32 s24, 0, s24
  s_lshl_b32 s5, s24, 10
  s_add_u32 m0, s23, s5
  s_mul_i32 s5, s24, 28672
  s_add_u32 s5, s5, s22
  buffer_load_dwordx4 v3, s[80:83], s5 offen lds
  s_add_u32 s24, s24, 1
  s_cmp_eq_u32 s24, 14
  s_cselect_b32 s24, 0, s24
  s_lshl_b32 s5, s24, 10
  s_add_u32 m0, s23, s5
  s_mul_i32 s5, s24, 28672
  s_add_u32 s5, s5, s22
  buffer_load_dwordx4 v3, s[80:83], s5 offen lds
L_dret:
L_d1:
  buffer_load_dword v16, v4, s[16:19], s55 offen sc1
  buffer_load_dword v17, v4, s[16:19], s60 offen sc1
  buffer_load_dword v18, v4, s[16:19], s61 offen sc1
  buffer_load_dword v19, v4, s[16:19], s62 offen sc1
  s_waitcnt vmcnt(0)
  v_bitop3_b32 v36, v16, v17, s72 bitop3:0x7e
  v_bitop3_b32 v37, v18, v19, s72 bitop3:0x7e
  v_bitop3_b32 v36, v36, v37, s48 bitop3:0xa8
  v_cmp_ne_u32 vcc, 0, v36
  s_cbranch_vccz L_d2
  s_sub_u32 s43, s43, 1
  s_cbranch_scc1 L_d2
  s_branch L_d1
L_d2:
  v_add_f32 v16, v16, v17
  v_add_f32 v18, v18, v19
  v_lshlrev_b32 v7, 16, v7
  v_add_f32 v41, v16, v18
  v_cvt_pk_bf16_f32 v41, v41, v41
  v_and_b32 v41, 0xffff0000, v41
  v_add_f32 v41, v41, v7
  v_cvt_pk_bf16_f32 v41, v41, v41
  v_and_b32 v41, 0xffff0000, v41
  s_waitcnt vmcnt(0)
  ds_read_b64_tr_b16 v[68:69], v39 offset:5376
  ds_read_b64_tr_b16 v[70:71], v39 offset:5504
  ds_read_b64_tr_b16 v[72:73], v39 offset:6400
  ds_read_b64_tr_b16 v[74:75], v39 offset:6528
  ds_read_b64_tr_b16 v[76:77], v39 offset:7424
  ds_read_b64_tr_b16 v[78:79], v39 offset:7552
  ds_read_b64_tr_b16 v[80:81], v39 offset:8448
  ds_read_b64_tr_b16 v[82:83], v39 offset:8576
  ds_read_b64_tr_b16 v[84:85], v39 offset:9472
  ds_read_b64_tr_b16 v[86:87], v39 offset:9600
  ds_read_b64_tr_b16 v[88:89], v39 offset:10496
  ds_read_b64_tr_b16 v[90:91], v39 offset:10624
  ds_read_b64_tr_b16 v[92:93], v39 offset:11520
  ds_read_b64_tr_b16 v[94:95], v39 offset:11648
  ds_read_b64_tr_b16 v[96:97], v39 offset:12544
  ds_read_b64_tr_b16 v[98:99], v39 offset:12672
  ds_read_b64_tr_b16 v[100:101], v39 offset:13568
  ds_read_b64_tr_b16 v[102:103], v39 offset:13696
  ds_read_b64_tr_b16 v[104:105], v39 offset:14592
  ds_read_b64_tr_b16 v[106:107], v39 offset:14720
  ds_read_b64_tr_b16 v[108:109], v39 offset:15616
  ds_read_b64_tr_b16 v[110:111], v39 offset:15744
  ds_read_b64_tr_b16 v[112:113], v39 offset:16640
  ds_read_b64_tr_b16 v[114:115], v39 offset:16768
  ds_read_b64_tr_b16 v[116:117], v39 offset:17664
  ds_read_b64_tr_b16 v[118:119], v39 offset:17792
  ds_read_b64_tr_b16 v[120:121], v39 offset:18688
  ds_read_b64_tr_b16 v[122:123], v39 offset:18816
  s_waitcnt lgkmcnt(0)
L_dl2:
  buffer_load_dwordx4 v[124:127], v2, s[16:19], s25 offen offset:0 sc1
  buffer_load_dwordx4 v[128:131], v2, s[16:19], s25 offen offset:1024 sc1
  buffer_load_dwordx4 v[132:135], v2, s[16:19], s25 offen offset:2048 sc1
  buffer_load_dwordx4 v[136:139], v38, s[16:19], s25 offen offset:3072 sc1
  s_waitcnt vmcnt(3)
  v_max_u32 v36, v124, v126
  v_mfma_f32_16x16x32_bf16 v[140:143], v[68:71], v[124:127], 0
  v_mfma_f32_16x16x32_bf16 v[144:147], v[72:75], v[124:127], 0
  v_mfma_f32_16x16x32_bf16 v[148:151], v[76:79], v[124:127], 0
  v_mfma_f32_16x16x32_bf16 v[152:155], v[80:83], v[124:127], 0
  s_waitcnt vmcnt(2)
  v_max3_u32 v36, v128, v130, v36
  v_mfma_f32_16x16x32_bf16 v[140:143], v[84:87], v[128:131], v[140:143]
  v_mfma_f32_16x16x32_bf16 v[144:147], v[88:91], v[128:131], v[144:147]
  v_mfma_f32_16x16x32_bf16 v[148:151], v[92:95], v[128:131], v[148:151]
  v_mfma_f32_16x16x32_bf16 v[152:155], v[96:99], v[128:131], v[152:155]
  s_waitcnt vmcnt(1)
  v_max3_u32 v36, v132, v134, v36
  v_mfma_f32_16x16x32_bf16 v[140:143], v[100:103], v[132:135], v[140:143]
  v_mfma_f32_16x16x32_bf16 v[144:147], v[104:107], v[132:135], v[144:147]
  v_mfma_f32_16x16x32_bf16 v[148:151], v[108:111], v[132:135], v[148:151]
  v_mfma_f32_16x16x32_bf16 v[152:155], v[112:115], v[132:135], v[152:155]
  s_waitcnt vmcnt(0)
  v_max3_u32 v36, v136, v138, v36
  v_cmp_eq_u32 vcc, -1, v36
  v_mfma_f32_16x16x32_bf16 v[140:143], v[116:119], v[136:139], v[140:143]
  v_mfma_f32_16x16x32_bf16 v[144:147], v[120:123], v[136:139], v[144:147]
  s_cbranch_vccz L_dd
  s_sub_u32 s43, s43, 1
  s_cbranch_scc0 L_dl2
L_dd:
  s_nop 1
  v_add_f32_dpp v148, v152, v148 row_shl:4 row_mask:0xf bank_mask:0xf bound_ctrl:0
  v_add_f32_dpp v149, v153, v149 row_shl:4 row_mask:0xf bank_mask:0xf bound_ctrl:0
  v_add_f32_dpp v150, v154, v150 row_shl:4 row_mask:0xf bank_mask:0xf bound_ctrl:0
  v_add_f32_dpp v151, v155, v151 row_shl:4 row_mask:0xf bank_mask:0xf bound_ctrl:0
  s_nop 0
  v_add_f32_dpp v140, v144, v140 row_shl:4 row_mask:0xf bank_mask:0xf bound_ctrl:0
  v_add_f32_dpp v141, v145, v141 row_shl:4 row_mask:0xf bank_mask:0xf bound_ctrl:0
  v_add_f32_dpp v142, v146, v142 row_shl:4 row_mask:0xf bank_mask:0xf bound_ctrl:0
  v_add_f32_dpp v143, v147, v143 row_shl:4 row_mask:0xf bank_mask:0xf bound_ctrl:0
  v_add_f32_dpp v140, v148, v140 row_shl:8 row_mask:0xf bank_mask:0xf bound_ctrl:0
  v_add_f32_dpp v141, v149, v141 row_shl:8 row_mask:0xf bank_mask:0xf bound_ctrl:0
  v_add_f32_dpp v142, v150, v142 row_shl:8 row_mask:0xf bank_mask:0xf bound_ctrl:0
  v_add_f32_dpp v143, v151, v143 row_shl:8 row_mask:0xf bank_mask:0xf bound_ctrl:0
  s_and_b32 exec_lo, 0x000f000f, s68
  s_and_b32 exec_hi, 0x000f000f, s68
  ds_write_b128 v40, v[140:143] offset:0
  s_waitcnt lgkmcnt(0)
  s_barrier
L_dnb:
  s_and_b32 s5, s4, s68
  s_cbranch_scc1 L_fin
  s_mov_b64 exec, s[68:69]
  ds_read2st64_b32 v[68:69], v4 offset0:0 offset1:1
  ds_read2st64_b32 v[70:71], v4 offset0:2 offset1:3
  s_waitcnt lgkmcnt(0)
  v_pk_add_f32 v[68:69], v[68:69], v[70:71]
  v_add_f32 v68, v68, v69
  v_cvt_pk_bf16_f32 v68, v68, v68
  v_and_b32 v68, 0xffff0000, v68
  v_add_f32 v68, v68, v41
  v_cvt_pk_bf16_f32 v68, v68, v68
  buffer_store_short v68, v5, s[76:79], s56 offen
L_dx:
  s_endpgm
L_tchE:
  s_branch L_tchEr
L_notW:
  s_cmp_lg_u32 s74, 1
  s_cbranch_scc1 L_D
L_fi:
  s_mov_b32 s76, s60
  s_mov_b32 s77, s61
  s_mov_b32 m0, s22
  s_nop 0
  buffer_load_dwordx4 v244, s[76:79], 0 offen lds
  s_mov_b32 m0, s23
  s_nop 0
  buffer_load_dwordx4 v245, s[76:79], 0 offen lds
  s_mov_b32 m0, s24
  s_nop 0
  buffer_load_dwordx4 v246, s[76:79], 0 offen lds
  s_mov_b32 m0, s25
  s_nop 0
  buffer_load_dwordx4 v247, s[76:79], 0 offen lds
  s_mov_b32 s76, s62
  s_mov_b32 s77, s63
  s_add_u32 m0, s22, 14336
  s_nop 0
  buffer_load_dwordx4 v244, s[76:79], 0 offen lds
  s_add_u32 m0, s23, 14336
  s_nop 0
  buffer_load_dwordx4 v245, s[76:79], 0 offen lds
  s_add_u32 m0, s24, 14336
  s_nop 0
  buffer_load_dwordx4 v246, s[76:79], 0 offen lds
  s_add_u32 m0, s25, 14336
  s_nop 0
  buffer_load_dwordx4 v247, s[76:79], 0 offen lds
  v_and_b32 v9, 3, v1
  v_bfe_u32 v8, v1, 2, 2
  v_lshrrev_b32 v6, 4, v1
  v_mul_u32_u24 v2, 3584, v8
  v_lshl_add_u32 v2, v6, 6, v2
  v_lshl_add_u32 v2, v9, 4, v2
  v_lshl_add_u32 v40, v6, 3, v8
  v_lshlrev_b32 v40, 5, v40
  v_lshl_add_u32 v40, v9, 3, v40
  s_lshl_b32 s5, s58, 10
  v_add_u32 v40, s5, v40
  v_lshrrev_b32 v41, 2, v1
  v_mul_u32_u24 v41, 224, v41
  v_lshl_add_u32 v41, v9, 3, v41
  s_mul_i32 s5, s4, 3584
  v_add_u32 v41, s5, v41
  v_mov_b32 v132, s53
  v_mov_b32 v133, s53
  v_mov_b32 v134, s53
  v_mov_b32 v135, s53
  v_and_b32 v7, 15, v1
  v_lshlrev_b32 v7, 3, v7
  v_mul_u32_u24 v4, 136, v6
  v_add_u32 v7, v7, v4
  s_mul_i32 s5, s4, 544
  v_add_u32 v7, s5, v7
  v_lshrrev_b32 v15, 2, v1
  v_lshlrev_b32 v38, 3, v15
  v_mul_u32_u24 v4, 136, v9
  v_add_u32 v4, v4, v38
  s_lshl_b32 s5, s4, 5
  v_lshl_add_u32 v5, v6, 3, s5
  v_lshlrev_b32 v15, 3, v9
  s_lshl_b32 s5, s4, 7
  v_lshl_add_u32 v8, v1, 3, s5
  v_lshrrev_b32 v3, 1, v6
  v_mul_u32_u24 v3, 48, v3
  v_lshl_add_u32 v3, v6, 3, v3
  v_lshl_add_u32 v3, v9, 4, v3
  s_mul_i32 s54, s58, 256
  s_and_b32 s5, s2, 7
  s_mul_i32 s5, s5, 14592
  s_add_u32 s54, s54, s5
  s_add_u32 s54, s54, 2097152
  s_cmp_lt_u32 s4, 2
  s_cselect_b32 s55, s54, 4194304
  s_mul_i32 s25, s4, 29184
  s_lshl_b32 s5, s75, 7
  s_add_u32 s25, s25, s5
  s_add_u32 s25, s25, 2621440
  s_add_u32 s26, s25, 14592
  s_mov_b32 s6, 0x3d372713
  s_mov_b32 s7, 0xc0135761
  s_mov_b32 s59, 0x3b124925
  s_waitcnt vmcnt(0)
  ds_read_b64_tr_b16 v[68:69], v40 offset:5376
  ds_read_b64_tr_b16 v[70:71], v40 offset:5504
  ds_read_b64_tr_b16 v[84:85], v40 offset:19712
  ds_read_b64_tr_b16 v[86:87], v40 offset:19840
  ds_read_b64_tr_b16 v[72:73], v40 offset:6400
  ds_read_b64_tr_b16 v[74:75], v40 offset:6528
  ds_read_b64_tr_b16 v[88:89], v40 offset:20736
  ds_read_b64_tr_b16 v[90:91], v40 offset:20864
  ds_read_b64_tr_b16 v[76:77], v40 offset:7424
  ds_read_b64_tr_b16 v[78:79], v40 offset:7552
  ds_read_b64_tr_b16 v[92:93], v40 offset:21760
  ds_read_b64_tr_b16 v[94:95], v40 offset:21888
  ds_read_b64_tr_b16 v[80:81], v40 offset:8448
  ds_read_b64_tr_b16 v[82:83], v40 offset:8576
  ds_read_b64_tr_b16 v[96:97], v40 offset:22784
  ds_read_b64_tr_b16 v[98:99], v40 offset:22912
  s_cmp_lt_u32 s4, 2
  s_waitcnt lgkmcnt(0)
  s_cbranch_scc1 L_fz
  v_mov_b32 v80, 0
  v_mov_b32 v96, 0
  v_mov_b32 v81, 0
  v_mov_b32 v97, 0
  v_mov_b32 v82, 0
  v_mov_b32 v98, 0
  v_mov_b32 v83, 0
  v_mov_b32 v99, 0
L_fz:
  v_mfma_f32_16x16x32_bf16 v[16:19], v[132:135], v[68:71], 0
  v_mfma_f32_16x16x32_bf16 v[204:207], v[132:135], v[84:87], 0
  v_mfma_f32_16x16x32_bf16 v[16:19], v[132:135], v[72:75], v[16:19]
  v_mfma_f32_16x16x32_bf16 v[204:207], v[132:135], v[88:91], v[204:207]
  v_mfma_f32_16x16x32_bf16 v[16:19], v[132:135], v[76:79], v[16:19]
  v_mfma_f32_16x16x32_bf16 v[204:207], v[132:135], v[92:95], v[204:207]
  v_mfma_f32_16x16x32_bf16 v[16:19], v[132:135], v[80:83], v[16:19]
  v_mfma_f32_16x16x32_bf16 v[204:207], v[132:135], v[96:99], v[204:207]
  s_nop 7
  v_mov_b32 v17, v204
  s_mov_b64 exec, 0xffff
  ds_write_b64 v8, v[16:17] offset:4288
  s_mov_b64 exec, -1
  s_waitcnt lgkmcnt(0)
  s_barrier
  v_add_u32 v38, 4288, v38
  ds_read2_b64 v[244:247], v38 offset0:0 offset1:16
  ds_read2_b64 v[248:251], v38 offset0:32 offset1:48
  v_add_u32 v15, 4160, v15
  s_waitcnt lgkmcnt(0)
  v_pk_add_f32 v[244:245], v[244:245], v[246:247]
  v_pk_add_f32 v[248:249], v[248:249], v[250:251]
  v_pk_add_f32 v[36:37], v[244:245], v[248:249]
  buffer_load_dwordx4 v[116:119], v2, s[16:19], s54 offen offset:0 sc1
  buffer_load_dwordx4 v[120:123], v2, s[16:19], s54 offen offset:256 sc1
  buffer_load_dwordx4 v[124:127], v2, s[16:19], s54 offen offset:512 sc1
  buffer_load_dwordx4 v[128:131], v2, s[16:19], s55 offen offset:768 sc1
  s_branch L_fv
L_fl:
  buffer_load_dwordx4 v[116:119], v2, s[16:19], s54 offen offset:0 sc1
  buffer_load_dwordx4 v[120:123], v2, s[16:19], s54 offen offset:256 sc1
  buffer_load_dwordx4 v[124:127], v2, s[16:19], s54 offen offset:512 sc1
  buffer_load_dwordx4 v[128:131], v2, s[16:19], s55 offen offset:768 sc1
L_fv:
  s_waitcnt vmcnt(3)
  v_max_u32 v38, v116, v118
  v_mfma_f32_16x16x32_bf16 v[16:19], v[116:119], v[68:71], 0
  v_mfma_f32_16x16x32_bf16 v[204:207], v[116:119], v[84:87], 0
  v_mfma_f32_16x16x32_bf16 v[208:211], v[116:119], v[116:119], 0
  v_mfma_f32_16x16x32_bf16 v[212:215], v[132:135], v[116:119], 0
  s_waitcnt vmcnt(2)
  v_max3_u32 v38, v120, v122, v38
  v_mfma_f32_16x16x32_bf16 v[16:19], v[120:123], v[72:75], v[16:19]
  v_mfma_f32_16x16x32_bf16 v[204:207], v[120:123], v[88:91], v[204:207]
  v_mfma_f32_16x16x32_bf16 v[208:211], v[120:123], v[120:123], v[208:211]
  v_mfma_f32_16x16x32_bf16 v[212:215], v[132:135], v[120:123], v[212:215]
  s_waitcnt vmcnt(1)
  v_max3_u32 v38, v124, v126, v38
  v_mfma_f32_16x16x32_bf16 v[16:19], v[124:127], v[76:79], v[16:19]
  v_mfma_f32_16x16x32_bf16 v[204:207], v[124:127], v[92:95], v[204:207]
  v_mfma_f32_16x16x32_bf16 v[208:211], v[124:127], v[124:127], v[208:211]
  v_mfma_f32_16x16x32_bf16 v[212:215], v[132:135], v[124:127], v[212:215]
  s_waitcnt vmcnt(0)
  v_max3_u32 v38, v128, v130, v38
  v_cmp_eq_u32 vcc, -1, v38
  v_mfma_f32_16x16x32_bf16 v[16:19], v[128:131], v[80:83], v[16:19]
  v_mfma_f32_16x16x32_bf16 v[204:207], v[128:131], v[96:99], v[204:207]
  v_mfma_f32_16x16x32_bf16 v[208:211], v[128:131], v[128:131], v[208:211]
  v_mfma_f32_16x16x32_bf16 v[212:215], v[132:135], v[128:131], v[212:215]
  s_cbranch_vccz L_fd
  s_sub_u32 s43, s43, 1
  s_cbranch_scc0 L_fl
L_fd:
  s_nop 3
  v_permlane16_swap_b32 v16, v17
  v_permlane16_swap_b32 v18, v19
  v_permlane16_swap_b32 v204, v205
  v_permlane16_swap_b32 v206, v207
  v_permlane16_swap_b32 v208, v209
  v_permlane16_swap_b32 v210, v211
  v_add_f32 v16, v16, v17
  v_add_f32 v18, v18, v19
  v_add_f32 v204, v204, v205
  v_add_f32 v206, v206, v207
  v_add_f32 v208, v208, v209
  v_add_f32 v210, v210, v211
  v_add_f32_dpp v212, v212, v212 row_ror:4 row_mask:0xf bank_mask:0xf
  v_permlane32_swap_b32 v16, v18
  v_permlane32_swap_b32 v204, v206
  v_permlane32_swap_b32 v208, v210
  v_add_f32 v16, v16, v18
  v_add_f32 v17, v204, v206
  v_add_f32 v213, v208, v210
  v_add_f32_dpp v212, v212, v212 row_ror:8 row_mask:0xf bank_mask:0xf
  ds_write_b64 v7, v[16:17] offset:0
  v_add_f32_dpp v213, v213, v213 row_ror:4 row_mask:0xf bank_mask:0xf
  s_nop 1
  v_add_f32_dpp v213, v213, v213 row_ror:8 row_mask:0xf bank_mask:0xf
  s_and_b32 exec_lo, 0x00020001, s68
  s_and_b32 exec_hi, 0x00080004, s68
  ds_write_b64 v5, v[212:213] offset:4160
  s_waitcnt lgkmcnt(0)
  s_barrier
L_fnb:
  s_mov_b64 exec, s[68:69]
  ds_read2_b64 v[244:247], v15 offset0:0 offset1:4
  ds_read2_b64 v[248:251], v15 offset0:8 offset1:12
  ds_read2_b64 v[204:207], v4 offset0:0 offset1:68
  ds_read2_b64 v[208:211], v4 offset0:136 offset1:204
  s_waitcnt lgkmcnt(2)
  v_pk_add_f32 v[244:245], v[244:245], v[246:247]
  v_pk_add_f32 v[248:249], v[248:249], v[250:251]
  v_pk_add_f32 v[244:245], v[244:245], v[248:249]
  v_mul_f32 v244, s59, v244
  v_mul_f32 v245, s59, v245
  v_fma_f32 v245, -v244, v244, v245
  v_max_f32 v245, 0, v245
  v_cvt_pk_bf16_f32 v245, v244, v245
  v_lshlrev_b32 v244, 16, v245
  v_and_b32 v245, 0xffff0000, v245
  v_add_f32 v245, 0x3727c5ac, v245
  v_cvt_pk_bf16_f32 v245, v245, v245
  v_and_b32 v245, 0xffff0000, v245
  v_sqrt_f32 v245, v245
  s_waitcnt lgkmcnt(0)
  v_pk_add_f32 v[204:205], v[204:205], v[206:207]
  v_cvt_pk_bf16_f32 v245, v245, v245
  v_and_b32 v245, 0xffff0000, v245
  v_pk_add_f32 v[208:209], v[208:209], v[210:211]
  v_rcp_f32 v245, v245
  v_pk_add_f32 v[204:205], v[204:205], v[208:209]
  v_fma_f32 v204, -v244, v36, v204
  v_fma_f32 v205, -v244, v37, v205
  v_mul_f32 v204, v204, v245
  v_mul_f32 v205, v205, v245
  v_cvt_pk_bf16_f32 v205, v204, v205
  v_lshlrev_b32 v204, 16, v205
  v_and_b32 v205, 0xffff0000, v205
  v_mul_f32 v206, v204, v204
  v_mul_f32 v207, s7, v204
  v_fma_f32 v206, v206, s6, 1.0
  v_mul_f32 v206, v206, v207
  v_exp_f32 v206, v206
  s_nop 0
  v_add_f32 v206, 1.0, v206
  v_rcp_f32 v206, v206
  s_nop 0
  v_mul_f32 v206, v206, v204
  v_cvt_pk_bf16_f32 v206, v206, v206
  v_and_b32 v206, 0xffff0000, v206
  v_mul_f32 v206, v206, v205
  s_nop 1
  v_mov_b32_dpp v207, v206 row_shl:4 row_mask:0xf bank_mask:0xf bound_ctrl:0
  v_cvt_pk_bf16_f32 v16, v206, v207
  s_nop 1
  v_mov_b32_dpp v17, v16 row_shl:8 row_mask:0xf bank_mask:0xf bound_ctrl:0
  s_and_b32 exec_lo, 0x000f000f, s68
  s_and_b32 exec_hi, 0x000f000f, s68
  v_min_u32 v16, -2, v16
  buffer_store_dwordx2 v[16:17], v3, s[16:19], s25 offen sc1
  buffer_store_dwordx2 v[16:17], v3, s[16:19], s26 offen sc1
L_fx:
L_fin:
L_exit:
  s_endpgm
L_dA:
  s_waitcnt vmcnt(16)
  v_and_b32_dpp v28, v219, v10 row_newbcast:0 row_mask:0xf bank_mask:0xf
  v_and_b32_dpp v29, v219, v11 row_newbcast:0 row_mask:0xf bank_mask:0xf
  v_and_b32_dpp v30, v219, v12 row_newbcast:0 row_mask:0xf bank_mask:0xf
  v_and_b32_dpp v31, v219, v13 row_newbcast:0 row_mask:0xf bank_mask:0xf
  s_nop 1
  v_mfma_f32_16x16x32_bf16 v[20:23], v[100:103], v[28:31], v[20:23]
  v_mfma_f32_16x16x32_bf16 v[24:27], v[104:107], v[28:31], v[24:27]
  v_and_b32_dpp v32, v219, v10 row_newbcast:4 row_mask:0xf bank_mask:0xf
  v_and_b32_dpp v33, v219, v11 row_newbcast:4 row_mask:0xf bank_mask:0xf
  v_and_b32_dpp v34, v219, v12 row_newbcast:4 row_mask:0xf bank_mask:0xf
  v_and_b32_dpp v35, v219, v13 row_newbcast:4 row_mask:0xf bank_mask:0xf
  s_nop 1
  v_mfma_f32_16x16x32_bf16 v[20:23], v[108:111], v[32:35], v[20:23]
  v_mfma_f32_16x16x32_bf16 v[24:27], v[112:115], v[32:35], v[24:27]
  v_and_b32_dpp v28, v219, v10 row_newbcast:8 row_mask:0xf bank_mask:0xf
  v_and_b32_dpp v29, v219, v11 row_newbcast:8 row_mask:0xf bank_mask:0xf
  v_and_b32_dpp v30, v219, v12 row_newbcast:8 row_mask:0xf bank_mask:0xf
  v_and_b32_dpp v31, v219, v13 row_newbcast:8 row_mask:0xf bank_mask:0xf
  s_nop 1
  v_mfma_f32_16x16x32_bf16 v[20:23], v[116:119], v[28:31], v[20:23]
  v_mfma_f32_16x16x32_bf16 v[24:27], v[120:123], v[28:31], v[24:27]
  v_and_b32_dpp v32, v219, v10 row_newbcast:12 row_mask:0xf bank_mask:0xf
  v_and_b32_dpp v33, v219, v11 row_newbcast:12 row_mask:0xf bank_mask:0xf
  v_and_b32_dpp v34, v219, v12 row_newbcast:12 row_mask:0xf bank_mask:0xf
  v_and_b32_dpp v35, v219, v13 row_newbcast:12 row_mask:0xf bank_mask:0xf
  s_nop 1
  v_mfma_f32_16x16x32_bf16 v[20:23], v[124:127], v[32:35], v[20:23]
  v_mfma_f32_16x16x32_bf16 v[24:27], v[128:131], v[32:35], v[24:27]
  s_waitcnt vmcnt(8)
  v_and_b32_dpp v28, v220, v10 row_newbcast:0 row_mask:0xf bank_mask:0xf
  v_and_b32_dpp v29, v220, v11 row_newbcast:0 row_mask:0xf bank_mask:0xf
  v_and_b32_dpp v30, v220, v12 row_newbcast:0 row_mask:0xf bank_mask:0xf
  v_and_b32_dpp v31, v220, v13 row_newbcast:0 row_mask:0xf bank_mask:0xf
  s_nop 1
  v_mfma_f32_16x16x32_bf16 v[20:23], v[132:135], v[28:31], v[20:23]
  v_mfma_f32_16x16x32_bf16 v[24:27], v[136:139], v[28:31], v[24:27]
  v_and_b32_dpp v32, v220, v10 row_newbcast:4 row_mask:0xf bank_mask:0xf
  v_and_b32_dpp v33, v220, v11 row_newbcast:4 row_mask:0xf bank_mask:0xf
  v_and_b32_dpp v34, v220, v12 row_newbcast:4 row_mask:0xf bank_mask:0xf
  v_and_b32_dpp v35, v220, v13 row_newbcast:4 row_mask:0xf bank_mask:0xf
  s_nop 1
  v_mfma_f32_16x16x32_bf16 v[20:23], v[140:143], v[32:35], v[20:23]
  v_mfma_f32_16x16x32_bf16 v[24:27], v[144:147], v[32:35], v[24:27]
  v_and_b32_dpp v28, v220, v10 row_newbcast:8 row_mask:0xf bank_mask:0xf
  v_and_b32_dpp v29, v220, v11 row_newbcast:8 row_mask:0xf bank_mask:0xf
  v_and_b32_dpp v30, v220, v12 row_newbcast:8 row_mask:0xf bank_mask:0xf
  v_and_b32_dpp v31, v220, v13 row_newbcast:8 row_mask:0xf bank_mask:0xf
  s_nop 1
  v_mfma_f32_16x16x32_bf16 v[20:23], v[148:151], v[28:31], v[20:23]
  v_mfma_f32_16x16x32_bf16 v[24:27], v[152:155], v[28:31], v[24:27]
  v_and_b32_dpp v32, v220, v10 row_newbcast:12 row_mask:0xf bank_mask:0xf
  v_and_b32_dpp v33, v220, v11 row_newbcast:12 row_mask:0xf bank_mask:0xf
  v_and_b32_dpp v34, v220, v12 row_newbcast:12 row_mask:0xf bank_mask:0xf
  v_and_b32_dpp v35, v220, v13 row_newbcast:12 row_mask:0xf bank_mask:0xf
  s_nop 1
  v_mfma_f32_16x16x32_bf16 v[20:23], v[156:159], v[32:35], v[20:23]
  v_mfma_f32_16x16x32_bf16 v[24:27], v[160:163], v[32:35], v[24:27]
  v_add_f32_dpp v4, v4, v4 row_ror:4 row_mask:0xf bank_mask:0xf
  s_nop 1
  v_add_f32_dpp v4, v4, v4 row_ror:8 row_mask:0xf bank_mask:0xf
  s_nop 1
  v_add_f32_dpp v4, v4, v4 row_bcast:15 row_mask:0xa bank_mask:0xf
  s_nop 1
  v_add_f32_dpp v4, v4, v4 row_bcast:31 row_mask:0xc bank_mask:0xf
  s_nop 0
  v_readlane_b32 s39, v4, 63
  s_nop 1
  v_mov_b32 v8, s39
  ds_write_b32 v254, v5 offset:4096
  ds_write_b32 v254, v8 offset:4100
  s_waitcnt vmcnt(0)
  v_and_b32_dpp v28, v221, v10 row_newbcast:0 row_mask:0xf bank_mask:0xf
  v_and_b32_dpp v29, v221, v11 row_newbcast:0 row_mask:0xf bank_mask:0xf
  v_and_b32_dpp v30, v221, v12 row_newbcast:0 row_mask:0xf bank_mask:0xf
  v_and_b32_dpp v31, v221, v13 row_newbcast:0 row_mask:0xf bank_mask:0xf
  s_nop 1
  v_mfma_f32_16x16x32_bf16 v[20:23], v[164:167], v[28:31], v[20:23]
  v_mfma_f32_16x16x32_bf16 v[24:27], v[168:171], v[28:31], v[24:27]
  v_and_b32_dpp v32, v221, v10 row_newbcast:4 row_mask:0xf bank_mask:0xf
  v_and_b32_dpp v33, v221, v11 row_newbcast:4 row_mask:0xf bank_mask:0xf
  v_and_b32_dpp v34, v221, v12 row_newbcast:4 row_mask:0xf bank_mask:0xf
  v_and_b32_dpp v35, v221, v13 row_newbcast:4 row_mask:0xf bank_mask:0xf
  s_nop 1
  v_mfma_f32_16x16x32_bf16 v[20:23], v[172:175], v[32:35], v[20:23]
  v_mfma_f32_16x16x32_bf16 v[24:27], v[176:179], v[32:35], v[24:27]
  v_and_b32_dpp v28, v221, v10 row_newbcast:8 row_mask:0xf bank_mask:0xf
  v_and_b32_dpp v29, v221, v11 row_newbcast:8 row_mask:0xf bank_mask:0xf
  v_and_b32_dpp v30, v221, v12 row_newbcast:8 row_mask:0xf bank_mask:0xf
  v_and_b32_dpp v31, v221, v13 row_newbcast:8 row_mask:0xf bank_mask:0xf
  s_nop 1
  v_mfma_f32_16x16x32_bf16 v[20:23], v[180:183], v[28:31], v[20:23]
  v_mfma_f32_16x16x32_bf16 v[24:27], v[184:187], v[28:31], v[24:27]
  v_and_b32_dpp v32, v221, v10 row_newbcast:12 row_mask:0xf bank_mask:0xf
  v_and_b32_dpp v33, v221, v11 row_newbcast:12 row_mask:0xf bank_mask:0xf
  v_and_b32_dpp v34, v221, v12 row_newbcast:12 row_mask:0xf bank_mask:0xf
  v_and_b32_dpp v35, v221, v13 row_newbcast:12 row_mask:0xf bank_mask:0xf
  s_nop 1
  v_mfma_f32_16x16x32_bf16 v[20:23], v[188:191], v[32:35], v[20:23]
  v_mfma_f32_16x16x32_bf16 v[24:27], v[192:195], v[32:35], v[24:27]
  s_branch L_le
L_dB:
  s_waitcnt vmcnt(8)
  v_and_b32_dpp v28, v221, v10 row_newbcast:0 row_mask:0xf bank_mask:0xf
  v_and_b32_dpp v29, v221, v11 row_newbcast:0 row_mask:0xf bank_mask:0xf
  v_and_b32_dpp v30, v221, v12 row_newbcast:0 row_mask:0xf bank_mask:0xf
  v_and_b32_dpp v31, v221, v13 row_newbcast:0 row_mask:0xf bank_mask:0xf
  s_nop 1
  v_mfma_f32_16x16x32_bf16 v[20:23], v[164:167], v[28:31], v[20:23]
  v_mfma_f32_16x16x32_bf16 v[24:27], v[168:171], v[28:31], v[24:27]
  v_and_b32_dpp v32, v221, v10 row_newbcast:4 row_mask:0xf bank_mask:0xf
  v_and_b32_dpp v33, v221, v11 row_newbcast:4 row_mask:0xf bank_mask:0xf
  v_and_b32_dpp v34, v221, v12 row_newbcast:4 row_mask:0xf bank_mask:0xf
  v_and_b32_dpp v35, v221, v13 row_newbcast:4 row_mask:0xf bank_mask:0xf
  s_nop 1
  v_mfma_f32_16x16x32_bf16 v[20:23], v[172:175], v[32:35], v[20:23]
  v_mfma_f32_16x16x32_bf16 v[24:27], v[176:179], v[32:35], v[24:27]
  v_and_b32_dpp v28, v221, v10 row_newbcast:8 row_mask:0xf bank_mask:0xf
  v_and_b32_dpp v29, v221, v11 row_newbcast:8 row_mask:0xf bank_mask:0xf
  v_and_b32_dpp v30, v221, v12 row_newbcast:8 row_mask:0xf bank_mask:0xf
  v_and_b32_dpp v31, v221, v13 row_newbcast:8 row_mask:0xf bank_mask:0xf
  s_nop 1
  v_mfma_f32_16x16x32_bf16 v[20:23], v[180:183], v[28:31], v[20:23]
  v_mfma_f32_16x16x32_bf16 v[24:27], v[184:187], v[28:31], v[24:27]
  v_and_b32_dpp v32, v221, v10 row_newbcast:12 row_mask:0xf bank_mask:0xf
  v_and_b32_dpp v33, v221, v11 row_newbcast:12 row_mask:0xf bank_mask:0xf
  v_and_b32_dpp v34, v221, v12 row_newbcast:12 row_mask:0xf bank_mask:0xf
  v_and_b32_dpp v35, v221, v13 row_newbcast:12 row_mask:0xf bank_mask:0xf
  s_nop 1
  v_mfma_f32_16x16x32_bf16 v[20:23], v[188:191], v[32:35], v[20:23]
  v_mfma_f32_16x16x32_bf16 v[24:27], v[192:195], v[32:35], v[24:27]
  s_branch L_dE
  s_endpgm
.section .rodata,"a"
.p2align 6
.amdhsa_kernel sequential_preLN__mha_block_cached__glu_gated_geglu__decode_kernel
  .amdhsa_next_free_vgpr 256
  .amdhsa_next_free_sgpr 102
  .amdhsa_accum_offset 256
  .amdhsa_group_segment_fixed_size 0
  .amdhsa_kernarg_size 96
  .amdhsa_user_sgpr_count 2
  .amdhsa_user_sgpr_kernarg_segment_ptr 1
  .amdhsa_system_sgpr_workgroup_id_x 1
.end_amdhsa_kernel
```
